```python
import torch

def _softmax(x, axis=-1):
    return torch.softmax(x, dim=axis)
def _gelu(x):
    return torch.nn.functional.gelu(x, approximate="tanh")
def _silu(x):
    return torch.nn.functional.silu(x)
def _sigmoid(x):
    return torch.sigmoid(x)
def _layernorm(x, axis=-1, eps=1e-5):
    m = x.mean(dim=axis, keepdim=True)
    v = x.var(dim=axis, keepdim=True, unbiased=False)
    return (x - m) / torch.sqrt(v + eps)
def _scatter_add(tgt, idx, src, axis=0):
    return tgt.clone().index_add_(axis, idx, src)
def _segment_sum(src, seg, n):
    out = torch.zeros((n,) + src.shape[1:], dtype=src.dtype)
    return out.index_add_(0, seg, src)
def _pad(x, pw):
    flat = tuple(v for pair in reversed(pw) for v in pair)
    return torch.nn.functional.pad(x, flat)

kernel_name = 'recurrent_scan__mha_block_cached__dense_activation_squared_relu__decode'

def setup_inputs():

    _w = (lambda a: (lambda t: t.to(torch.bfloat16) if t.is_floating_point() else t)(torch.as_tensor(a)))
    def _A_setup():
        B, Sq, D = 8, 1, 640
        H, Sk, Dh = 32, 4096, 192
        return {
            "x": _w((lambda *s: torch.randn(*s, dtype=torch.bfloat16) * 0.05)(B, Sq, D)),
            "k_cache": _w((lambda *s: torch.randn(*s, dtype=torch.bfloat16) * 0.8)(B, H, Sk, Dh)),
            "v_cache": _w((lambda *s: torch.randn(*s, dtype=torch.bfloat16) * 0.2)(B, H, Sk, Dh)),
            "wq": _w((lambda *s: torch.randn(*s, dtype=torch.bfloat16) * 0.8)(D, H * Dh) * (D ** -0.5)),
            "wo": _w((lambda *s: torch.randn(*s, dtype=torch.bfloat16) * 0.2)(H * Dh, D) * ((H * Dh) ** -0.5)),
        }
    _A_in = _A_setup()

    def _B_setup():
        B, S, D, F = 8, 1, 640, 1536
        return {
            "x": _w((lambda *s: torch.randn(*s, dtype=torch.bfloat16) * 0.05)(B, S, D)),
            "w1": _w((lambda *s: torch.randn(*s, dtype=torch.bfloat16) * 0.1)(D, F)),
            "b1": _w((lambda *s: torch.randn(*s, dtype=torch.bfloat16) * 0.1)(F)),
            "w2": _w((lambda *s: torch.randn(*s, dtype=torch.bfloat16) * 0.1)(F, D)),
            "b2": _w((lambda *s: torch.randn(*s, dtype=torch.bfloat16) * 0.1)(D)),
        }
    _B_in = _B_setup()

    return {
        "A_x": _A_in["x"],
        "A_k_cache": _A_in["k_cache"],
        "A_v_cache": _A_in["v_cache"],
        "A_wq": _A_in["wq"],
        "A_wo": _A_in["wo"],
        "B_x": _B_in["x"],
        "B_w1": _B_in["w1"],
        "B_b1": _B_in["b1"],
        "B_w2": _B_in["w2"],
        "B_b2": _B_in["b2"],
    }

def reference(A_x, A_k_cache, A_v_cache, A_wq, A_wo, B_x, B_w1, B_b1, B_w2, B_b2):
    def _A_ref(x, k_cache, v_cache, wq, wo):
        B, Sq, D = x.shape
        H, Dh = 32, 192
        q = (lambda x, *d: x.permute(*d))((x @ wq).reshape(B, Sq, H, Dh), 0, 2, 1, 3)
        scores = torch.einsum("bhqd,bhkd->bhqk", q, k_cache) * (Dh ** -0.5)
        p = _softmax(scores, axis=-1)
        o = torch.einsum("bhqk,bhkd->bhqd", p, v_cache)
        return (lambda x, *d: x.permute(*d))(o, 0, 2, 1, 3).reshape(B, Sq, H * Dh) @ wo

    def _B_ref(x, w1, b1, w2, b2):
        h = torch.einsum("bsd,df->bsf", x, w1) + b1
        zero = torch.zeros_like(h)
        r = torch.where(h > zero, h, zero)
        h = r * r
        out = torch.einsum("bsf,fd->bsd", h, w2) + b2
        return out

    x = A_x
    xn = _layernorm(x, axis=-1)
    s = _A_ref(xn, A_k_cache, A_v_cache, A_wq, A_wo)
    g = _silu(_B_ref(xn, B_w1, B_b1, B_w2, B_b2))
    return x + s * g
```

```asm
; @launch grid=(256,1,1) block=(512,1,1) lds=119040
.amdgcn_target "amdgcn-amd-amdhsa--gfx950"
.text
.globl recurrent_scan__mha_block_cached__dense_activation_squared_relu__decode_kernel
.p2align 8
.type recurrent_scan__mha_block_cached__dense_activation_squared_relu__decode_kernel,@function
recurrent_scan__mha_block_cached__dense_activation_squared_relu__decode_kernel:
    s_cmp_ge_u32 s2, 256
    s_cbranch_scc1 L_end
    s_load_dwordx16 s[4:19], s[0:1], 0
    s_load_dwordx8 s[20:27], s[0:1], 64
    s_load_dwordx2 s[28:29], s[0:1], 96
    s_memrealtime s[0:1]
    v_lshrrev_b32 v2, 6, v0
    v_and_b32 v1, 63, v0
    v_readfirstlane_b32 s3, v2
    s_lshr_b32 s30, s2, 5
    s_and_b32 s59, s2, 7
    s_lshr_b32 s60, s2, 3
    s_and_b32 s60, s60, 3
    s_lshl_b32 s61, s59, 2
    s_add_u32 s31, s61, s60
    s_mul_i32 s61, s59, 3
    s_add_u32 s61, s61, s60
    s_cmp_eq_u32 s60, 3
    s_cselect_b32 s101, 99, s61
    s_lshl_b32 s100, s30, 5
    s_add_u32 s100, s100, s31
    v_lshrrev_b32 v3, 3, v1
    v_and_b32 v4, 7, v1
    s_add_u32 s65, s3, s30
    s_and_b32 s65, s65, 7
    s_mul_i32 s59, s65, 80
    v_mul_u32_u24 v5, 10, v3
    v_add_u32 v5, s59, v5
    v_mul_u32_u24 v5, 12288, v5
    v_lshlrev_b32 v6, 4, v4
    v_add_u32 v5, v5, v6
    v_lshlrev_b32 v7, 2, v1
    s_mul_i32 s59, s30, 1280
    s_mul_i32 s60, s31, 384
    s_waitcnt lgkmcnt(0)
    s_mov_b32 s44, s10
    s_and_b32 s45, s11, 0xffff
    s_mov_b32 s46, 7864320
    s_mov_b32 s47, 0x20000
    s_cmp_lg_u32 s3, 7
    s_cbranch_scc1 L_not7_1
    s_mov_b32 s40, s4
    s_and_b32 s41, s5, 0xffff
    s_mov_b32 s42, 10240
    s_mov_b32 s43, 0x20000
    buffer_load_dword v52, v7, s[40:43], s59 offen offset:0
    buffer_load_dword v53, v7, s[40:43], s59 offen offset:256
    buffer_load_dword v54, v7, s[40:43], s59 offen offset:512
    buffer_load_dword v55, v7, s[40:43], s59 offen offset:768
    buffer_load_dword v56, v7, s[40:43], s59 offen offset:1024
    v_lshlrev_b32 v8, 2, v1
    v_mov_b32 v9, 0
    v_cmp_eq_u32 vcc, 36, v8
    s_mov_b32 exec_lo, 0xfffff
    s_mov_b32 exec_hi, 0
    v_cndmask_b32 v9, 0, 2, vcc
    ds_write_b32 v8, v9 offset:1968
    s_mov_b64 exec, -1
    s_waitcnt lgkmcnt(0)
L_not7_1:
    s_barrier
    s_cmp_lg_u32 s3, 3
    s_cbranch_scc1 L_notouch_2
    s_mov_b32 s32, s6
    s_and_b32 s33, s7, 0xffff
    s_mov_b32 s34, 402653184
    s_mov_b32 s35, 0x20000
    s_mov_b32 s36, s8
    s_and_b32 s37, s9, 0xffff
    s_mov_b32 s38, 402653184
    s_mov_b32 s39, 0x20000
    s_mul_i32 s56, s100, 1572864
    v_and_b32 v8, 1, v1
    v_mul_u32_u24 v8, 1572860, v8
    s_mov_b64 exec, 3
    buffer_load_dword v2, v8, s[32:35], s56 offen nt
    buffer_load_dword v2, v8, s[36:39], s56 offen nt
    s_mov_b64 exec, -1
L_notouch_2:
    s_cmp_lg_u32 s3, 7
    s_cbranch_scc1 L_wq_issue
    s_waitcnt vmcnt(0)
    v_mov_b32 v58, 0x3f803f80
    v_mov_b32 v59, 0
    v_mov_b32 v60, 0
    v_dot2c_f32_bf16 v59, v52, v58
    v_dot2c_f32_bf16 v60, v52, v52
    v_dot2c_f32_bf16 v59, v53, v58
    v_dot2c_f32_bf16 v60, v53, v53
    v_dot2c_f32_bf16 v59, v54, v58
    v_dot2c_f32_bf16 v60, v54, v54
    v_dot2c_f32_bf16 v59, v55, v58
    v_dot2c_f32_bf16 v60, v55, v55
    v_dot2c_f32_bf16 v59, v56, v58
    v_dot2c_f32_bf16 v60, v56, v56
    v_lshlrev_b32 v16, 16, v52
    v_and_b32 v17, 0xffff0000, v52
    v_lshlrev_b32 v18, 16, v53
    v_and_b32 v19, 0xffff0000, v53
    v_lshlrev_b32 v20, 16, v54
    v_and_b32 v21, 0xffff0000, v54
    v_lshlrev_b32 v22, 16, v55
    v_and_b32 v23, 0xffff0000, v55
    v_lshlrev_b32 v24, 16, v56
    v_and_b32 v25, 0xffff0000, v56
    v_add_f32_dpp v59, v59, v59 row_ror:8 row_mask:0xf bank_mask:0xf
    v_add_f32_dpp v60, v60, v60 row_ror:8 row_mask:0xf bank_mask:0xf
    s_nop 0
    v_add_f32_dpp v59, v59, v59 row_ror:4 row_mask:0xf bank_mask:0xf
    v_add_f32_dpp v60, v60, v60 row_ror:4 row_mask:0xf bank_mask:0xf
    s_nop 0
    v_add_f32_dpp v59, v59, v59 row_ror:2 row_mask:0xf bank_mask:0xf
    v_add_f32_dpp v60, v60, v60 row_ror:2 row_mask:0xf bank_mask:0xf
    s_nop 0
    v_add_f32_dpp v59, v59, v59 row_ror:1 row_mask:0xf bank_mask:0xf
    v_add_f32_dpp v60, v60, v60 row_ror:1 row_mask:0xf bank_mask:0xf
    v_readlane_b32 s66, v59, 0
    v_readlane_b32 s67, v59, 16
    v_readlane_b32 s68, v59, 32
    v_readlane_b32 s69, v59, 48
    v_mov_b32 v61, s66
    v_add_f32 v61, s67, v61
    v_add_f32 v61, s68, v61
    v_add_f32 v59, s69, v61
    v_readlane_b32 s70, v60, 0
    v_readlane_b32 s71, v60, 16
    v_readlane_b32 s72, v60, 32
    v_readlane_b32 s73, v60, 48
    v_mov_b32 v62, s70
    v_add_f32 v62, s71, v62
    v_add_f32 v62, s72, v62
    v_add_f32 v60, s73, v62
    v_mul_f32 v59, 0x3acccccd, v59
    v_mul_f32 v60, 0x3acccccd, v60
    v_fma_f32 v60, -v59, v59, v60
    v_max_f32 v60, 0, v60
    v_cvt_pk_bf16_f32 v59, 0, v59
    v_cvt_pk_bf16_f32 v60, 0, v60
    v_add_f32 v60, 0x3727c5ac, v60
    v_cvt_pk_bf16_f32 v60, 0, v60
    v_sqrt_f32 v60, v60
    s_nop 0
    v_cvt_pk_bf16_f32 v60, 0, v60
    v_rcp_f32 v61, v60
    v_sub_f32 v16, v16, v59
    v_sub_f32 v17, v17, v59
    v_sub_f32 v18, v18, v59
    v_sub_f32 v19, v19, v59
    v_sub_f32 v20, v20, v59
    v_sub_f32 v21, v21, v59
    v_sub_f32 v22, v22, v59
    v_sub_f32 v23, v23, v59
    v_sub_f32 v24, v24, v59
    v_sub_f32 v25, v25, v59
    v_cvt_pk_bf16_f32 v16, 0, v16
    v_cvt_pk_bf16_f32 v17, 0, v17
    v_cvt_pk_bf16_f32 v18, 0, v18
    v_cvt_pk_bf16_f32 v19, 0, v19
    v_cvt_pk_bf16_f32 v20, 0, v20
    v_cvt_pk_bf16_f32 v21, 0, v21
    v_cvt_pk_bf16_f32 v22, 0, v22
    v_cvt_pk_bf16_f32 v23, 0, v23
    v_cvt_pk_bf16_f32 v24, 0, v24
    v_cvt_pk_bf16_f32 v25, 0, v25
    v_mul_f32 v28, v16, v61
    v_mul_f32 v29, v17, v61
    v_mul_f32 v30, v18, v61
    v_mul_f32 v31, v19, v61
    v_mul_f32 v32, v20, v61
    v_mul_f32 v33, v21, v61
    v_mul_f32 v34, v22, v61
    v_mul_f32 v35, v23, v61
    v_mul_f32 v36, v24, v61
    v_mul_f32 v37, v25, v61
    v_fma_f32 v38, -v28, v60, v16
    v_fma_f32 v39, -v29, v60, v17
    v_fma_f32 v40, -v30, v60, v18
    v_fma_f32 v41, -v31, v60, v19
    v_fma_f32 v42, -v32, v60, v20
    v_fma_f32 v43, -v33, v60, v21
    v_fma_f32 v44, -v34, v60, v22
    v_fma_f32 v45, -v35, v60, v23
    v_fma_f32 v46, -v36, v60, v24
    v_fma_f32 v47, -v37, v60, v25
    v_fma_f32 v16, v38, v61, v28
    v_fma_f32 v17, v39, v61, v29
    v_fma_f32 v18, v40, v61, v30
    v_fma_f32 v19, v41, v61, v31
    v_fma_f32 v20, v42, v61, v32
    v_fma_f32 v21, v43, v61, v33
    v_fma_f32 v22, v44, v61, v34
    v_fma_f32 v23, v45, v61, v35
    v_fma_f32 v24, v46, v61, v36
    v_fma_f32 v25, v47, v61, v37
    v_cvt_pk_bf16_f32 v52, v16, v17
    v_cvt_pk_bf16_f32 v53, v18, v19
    v_cvt_pk_bf16_f32 v54, v20, v21
    v_cvt_pk_bf16_f32 v55, v22, v23
    v_cvt_pk_bf16_f32 v56, v24, v25
    ds_write_b32 v7, v52 offset:0
    ds_write_b32 v7, v53 offset:256
    ds_write_b32 v7, v54 offset:512
    ds_write_b32 v7, v55 offset:768
    ds_write_b32 v7, v56 offset:1024
    v_mov_b32 v8, 0
    v_mov_b32 v9, 1
    s_waitcnt lgkmcnt(0)
    ds_write_b32 v8, v9 offset:1992
L_wq_issue:
    s_mul_i32 s61, s30, 12288
    s_add_u32 s60, s60, s61
    s_mov_b32 s62, s30
    buffer_load_dwordx4 v[160:163], v5, s[44:47], s60 offen offset:0
    buffer_load_dwordx4 v[164:167], v5, s[44:47], s60 offen offset:128
    buffer_load_dwordx4 v[168:171], v5, s[44:47], s60 offen offset:256
    s_add_u32 s60, s60, 12288
    s_add_u32 s62, s62, 1
    s_cmp_eq_u32 s62, 10
    s_cselect_b32 s61, 122880, 0
    s_sub_u32 s60, s60, s61
    buffer_load_dwordx4 v[172:175], v5, s[44:47], s60 offen offset:0
    buffer_load_dwordx4 v[176:179], v5, s[44:47], s60 offen offset:128
    buffer_load_dwordx4 v[180:183], v5, s[44:47], s60 offen offset:256
    s_add_u32 s60, s60, 12288
    s_add_u32 s62, s62, 1
    s_cmp_eq_u32 s62, 10
    s_cselect_b32 s61, 122880, 0
    s_sub_u32 s60, s60, s61
    buffer_load_dwordx4 v[64:67], v5, s[44:47], s60 offen offset:0
    buffer_load_dwordx4 v[68:71], v5, s[44:47], s60 offen offset:128
    buffer_load_dwordx4 v[72:75], v5, s[44:47], s60 offen offset:256
    s_add_u32 s60, s60, 12288
    s_add_u32 s62, s62, 1
    s_cmp_eq_u32 s62, 10
    s_cselect_b32 s61, 122880, 0
    s_sub_u32 s60, s60, s61
    buffer_load_dwordx4 v[76:79], v5, s[44:47], s60 offen offset:0
    buffer_load_dwordx4 v[80:83], v5, s[44:47], s60 offen offset:128
    buffer_load_dwordx4 v[84:87], v5, s[44:47], s60 offen offset:256
    s_add_u32 s60, s60, 12288
    s_add_u32 s62, s62, 1
    s_cmp_eq_u32 s62, 10
    s_cselect_b32 s61, 122880, 0
    s_sub_u32 s60, s60, s61
    buffer_load_dwordx4 v[88:91], v5, s[44:47], s60 offen offset:0
    buffer_load_dwordx4 v[92:95], v5, s[44:47], s60 offen offset:128
    buffer_load_dwordx4 v[96:99], v5, s[44:47], s60 offen offset:256
    s_add_u32 s60, s60, 12288
    s_add_u32 s62, s62, 1
    s_cmp_eq_u32 s62, 10
    s_cselect_b32 s61, 122880, 0
    s_sub_u32 s60, s60, s61
    buffer_load_dwordx4 v[100:103], v5, s[44:47], s60 offen offset:0
    buffer_load_dwordx4 v[104:107], v5, s[44:47], s60 offen offset:128
    buffer_load_dwordx4 v[108:111], v5, s[44:47], s60 offen offset:256
    s_add_u32 s60, s60, 12288
    s_add_u32 s62, s62, 1
    s_cmp_eq_u32 s62, 10
    s_cselect_b32 s61, 122880, 0
    s_sub_u32 s60, s60, s61
    buffer_load_dwordx4 v[112:115], v5, s[44:47], s60 offen offset:0
    buffer_load_dwordx4 v[116:119], v5, s[44:47], s60 offen offset:128
    buffer_load_dwordx4 v[120:123], v5, s[44:47], s60 offen offset:256
    s_add_u32 s60, s60, 12288
    s_add_u32 s62, s62, 1
    s_cmp_eq_u32 s62, 10
    s_cselect_b32 s61, 122880, 0
    s_sub_u32 s60, s60, s61
    buffer_load_dwordx4 v[124:127], v5, s[44:47], s60 offen offset:0
    buffer_load_dwordx4 v[128:131], v5, s[44:47], s60 offen offset:128
    buffer_load_dwordx4 v[132:135], v5, s[44:47], s60 offen offset:256
    s_add_u32 s60, s60, 12288
    s_add_u32 s62, s62, 1
    s_cmp_eq_u32 s62, 10
    s_cselect_b32 s61, 122880, 0
    s_sub_u32 s60, s60, s61
    buffer_load_dwordx4 v[136:139], v5, s[44:47], s60 offen offset:0
    buffer_load_dwordx4 v[140:143], v5, s[44:47], s60 offen offset:128
    buffer_load_dwordx4 v[144:147], v5, s[44:47], s60 offen offset:256
    s_add_u32 s60, s60, 12288
    s_add_u32 s62, s62, 1
    s_cmp_eq_u32 s62, 10
    s_cselect_b32 s61, 122880, 0
    s_sub_u32 s60, s60, s61
    buffer_load_dwordx4 v[148:151], v5, s[44:47], s60 offen offset:0
    buffer_load_dwordx4 v[152:155], v5, s[44:47], s60 offen offset:128
    buffer_load_dwordx4 v[156:159], v5, s[44:47], s60 offen offset:256
    s_cmp_lt_u32 s3, 4
    s_cbranch_scc1 L_nobx_3
    v_mov_b32 v8, 0
    v_mov_b32 v9, 1
    s_mov_b64 exec, 1
    ds_add_u32 v8, v9 offset:1968
    s_mov_b64 exec, -1
L_nobx_3:
L_nobx2_4:
    v_and_b32 v8, 3, v3
    v_lshrrev_b32 v9, 2, v3
    v_mul_u32_u24 v9, 256, v9
    v_add_u32 v9, v9, v8
    v_mul_u32_u24 v9, 384, v9
    v_add_u32 v12, v9, v6
    s_mov_b32 s32, s6
    s_and_b32 s33, s7, 0xffff
    s_mov_b32 s34, 402653184
    s_mov_b32 s35, 0x20000
    s_mov_b32 s36, s8
    s_and_b32 s37, s9, 0xffff
    s_mov_b32 s38, 402653184
    s_mov_b32 s39, 0x20000
    s_mul_i32 s56, s100, 1572864
    s_mul_i32 s57, s2, 37
    s_add_u32 s57, s57, s3
    s_mov_b32 s58, s57
    s_mov_b32 s48, s26
    s_and_b32 s49, s27, 0xffff
    s_mov_b32 s50, 256
    s_mov_b32 s51, 0x20000
    s_mov_b32 s52, s28
    s_and_b32 s53, s29, 0xffff
    s_mov_b32 s54, 1610612736
    s_mov_b32 s55, 0x20000
    s_mov_b32 s64, 0x3dd53b95
    s_mul_i32 s66, s65, 160
    v_mul_u32_u24 v8, 20, v3
    v_add_u32 v8, s66, v8
    s_mov_b32 s66, s30
    s_lshl_b32 s67, s66, 1
    v_add_u32 v16, s67, v8
    s_add_u32 s66, s66, 1
    s_cmp_eq_u32 s66, 10
    s_cselect_b32 s66, 0, s66
    s_lshl_b32 s67, s66, 1
    v_add_u32 v17, s67, v8
    s_add_u32 s66, s66, 1
    s_cmp_eq_u32 s66, 10
    s_cselect_b32 s66, 0, s66
    s_lshl_b32 s67, s66, 1
    v_add_u32 v18, s67, v8
    s_add_u32 s66, s66, 1
    s_cmp_eq_u32 s66, 10
    s_cselect_b32 s66, 0, s66
    s_lshl_b32 s67, s66, 1
    v_add_u32 v19, s67, v8
    s_add_u32 s66, s66, 1
    s_cmp_eq_u32 s66, 10
    s_cselect_b32 s66, 0, s66
    s_lshl_b32 s67, s66, 1
    v_add_u32 v20, s67, v8
    s_add_u32 s66, s66, 1
    s_cmp_eq_u32 s66, 10
    s_cselect_b32 s66, 0, s66
    s_lshl_b32 s67, s66, 1
    v_add_u32 v21, s67, v8
    s_add_u32 s66, s66, 1
    s_cmp_eq_u32 s66, 10
    s_cselect_b32 s66, 0, s66
    s_lshl_b32 s67, s66, 1
    v_add_u32 v22, s67, v8
    s_add_u32 s66, s66, 1
    s_cmp_eq_u32 s66, 10
    s_cselect_b32 s66, 0, s66
    s_lshl_b32 s67, s66, 1
    v_add_u32 v23, s67, v8
    s_add_u32 s66, s66, 1
    s_cmp_eq_u32 s66, 10
    s_cselect_b32 s66, 0, s66
    s_lshl_b32 s67, s66, 1
    v_add_u32 v24, s67, v8
    s_add_u32 s66, s66, 1
    s_cmp_eq_u32 s66, 10
    s_cselect_b32 s66, 0, s66
    s_lshl_b32 s67, s66, 1
    v_add_u32 v25, s67, v8
    v_mov_b32 v28, 0
    v_mov_b32 v29, 0
    v_mov_b32 v30, 0
    v_mov_b32 v31, 0
    v_mov_b32 v32, 0
    v_mov_b32 v33, 0
    v_mov_b32 v34, 0
    v_mov_b32 v35, 0
    v_mov_b32 v36, 0
    v_mov_b32 v37, 0
    v_mov_b32 v38, 0
    v_mov_b32 v39, 0
    v_mov_b32 v40, 0
    v_mov_b32 v41, 0
    v_mov_b32 v42, 0
    v_mov_b32 v43, 0
    v_mov_b32 v44, 0
    v_mov_b32 v45, 0
    v_mov_b32 v46, 0
    v_mov_b32 v47, 0
    v_mov_b32 v48, 0
    v_mov_b32 v49, 0
    v_mov_b32 v50, 0
    v_mov_b32 v51, 0
    v_mov_b32 v8, 0
L_xspin_6:
    ds_read_b32 v9, v8 offset:1992
    s_waitcnt lgkmcnt(0)
    v_readfirstlane_b32 s66, v9
    s_nop 0
    s_cmp_eq_u32 s66, 1
    s_cbranch_scc0 L_xspin_6
    ds_read_u16 v16, v16 offset:0
    ds_read_u16 v17, v17 offset:0
    ds_read_u16 v18, v18 offset:0
    ds_read_u16 v19, v19 offset:0
    ds_read_u16 v20, v20 offset:0
    ds_read_u16 v21, v21 offset:0
    ds_read_u16 v22, v22 offset:0
    ds_read_u16 v23, v23 offset:0
    ds_read_u16 v24, v24 offset:0
    ds_read_u16 v25, v25 offset:0
    s_waitcnt lgkmcnt(0)
L_gathered_5:
    v_lshlrev_b32 v58, 16, v16
    s_waitcnt vmcnt(27)
    v_dot2c_f32_bf16 v28, v160, v16
    v_dot2c_f32_bf16 v29, v160, v58
    v_dot2c_f32_bf16 v30, v161, v16
    v_dot2c_f32_bf16 v31, v161, v58
    v_dot2c_f32_bf16 v32, v162, v16
    v_dot2c_f32_bf16 v33, v162, v58
    v_dot2c_f32_bf16 v34, v163, v16
    v_dot2c_f32_bf16 v35, v163, v58
    v_dot2c_f32_bf16 v36, v164, v16
    v_dot2c_f32_bf16 v37, v164, v58
    v_dot2c_f32_bf16 v38, v165, v16
    v_dot2c_f32_bf16 v39, v165, v58
    v_dot2c_f32_bf16 v40, v166, v16
    v_dot2c_f32_bf16 v41, v166, v58
    v_dot2c_f32_bf16 v42, v167, v16
    v_dot2c_f32_bf16 v43, v167, v58
    v_dot2c_f32_bf16 v44, v168, v16
    v_dot2c_f32_bf16 v45, v168, v58
    v_dot2c_f32_bf16 v46, v169, v16
    v_dot2c_f32_bf16 v47, v169, v58
    v_dot2c_f32_bf16 v48, v170, v16
    v_dot2c_f32_bf16 v49, v170, v58
    v_dot2c_f32_bf16 v50, v171, v16
    v_dot2c_f32_bf16 v51, v171, v58
    v_lshlrev_b32 v58, 16, v17
    s_waitcnt vmcnt(24)
    v_dot2c_f32_bf16 v28, v172, v17
    v_dot2c_f32_bf16 v29, v172, v58
    v_dot2c_f32_bf16 v30, v173, v17
    v_dot2c_f32_bf16 v31, v173, v58
    v_dot2c_f32_bf16 v32, v174, v17
    v_dot2c_f32_bf16 v33, v174, v58
    v_dot2c_f32_bf16 v34, v175, v17
    v_dot2c_f32_bf16 v35, v175, v58
    v_dot2c_f32_bf16 v36, v176, v17
    v_dot2c_f32_bf16 v37, v176, v58
    v_dot2c_f32_bf16 v38, v177, v17
    v_dot2c_f32_bf16 v39, v177, v58
    v_dot2c_f32_bf16 v40, v178, v17
    v_dot2c_f32_bf16 v41, v178, v58
    v_dot2c_f32_bf16 v42, v179, v17
    v_dot2c_f32_bf16 v43, v179, v58
    v_dot2c_f32_bf16 v44, v180, v17
    v_dot2c_f32_bf16 v45, v180, v58
    v_dot2c_f32_bf16 v46, v181, v17
    v_dot2c_f32_bf16 v47, v181, v58
    v_dot2c_f32_bf16 v48, v182, v17
    v_dot2c_f32_bf16 v49, v182, v58
    v_dot2c_f32_bf16 v50, v183, v17
    v_dot2c_f32_bf16 v51, v183, v58
    v_lshlrev_b32 v58, 16, v18
    s_waitcnt vmcnt(21)
    v_dot2c_f32_bf16 v28, v64, v18
    v_dot2c_f32_bf16 v29, v64, v58
    v_dot2c_f32_bf16 v30, v65, v18
    v_dot2c_f32_bf16 v31, v65, v58
    v_dot2c_f32_bf16 v32, v66, v18
    v_dot2c_f32_bf16 v33, v66, v58
    v_dot2c_f32_bf16 v34, v67, v18
    v_dot2c_f32_bf16 v35, v67, v58
    v_dot2c_f32_bf16 v36, v68, v18
    v_dot2c_f32_bf16 v37, v68, v58
    v_dot2c_f32_bf16 v38, v69, v18
    v_dot2c_f32_bf16 v39, v69, v58
    v_dot2c_f32_bf16 v40, v70, v18
    v_dot2c_f32_bf16 v41, v70, v58
    v_dot2c_f32_bf16 v42, v71, v18
    v_dot2c_f32_bf16 v43, v71, v58
    v_dot2c_f32_bf16 v44, v72, v18
    v_dot2c_f32_bf16 v45, v72, v58
    v_dot2c_f32_bf16 v46, v73, v18
    v_dot2c_f32_bf16 v47, v73, v58
    v_dot2c_f32_bf16 v48, v74, v18
    v_dot2c_f32_bf16 v49, v74, v58
    v_dot2c_f32_bf16 v50, v75, v18
    v_dot2c_f32_bf16 v51, v75, v58
    v_lshlrev_b32 v58, 16, v19
    s_waitcnt vmcnt(18)
    v_dot2c_f32_bf16 v28, v76, v19
    v_dot2c_f32_bf16 v29, v76, v58
    v_dot2c_f32_bf16 v30, v77, v19
    v_dot2c_f32_bf16 v31, v77, v58
    v_dot2c_f32_bf16 v32, v78, v19
    v_dot2c_f32_bf16 v33, v78, v58
    v_dot2c_f32_bf16 v34, v79, v19
    v_dot2c_f32_bf16 v35, v79, v58
    v_dot2c_f32_bf16 v36, v80, v19
    v_dot2c_f32_bf16 v37, v80, v58
    v_dot2c_f32_bf16 v38, v81, v19
    v_dot2c_f32_bf16 v39, v81, v58
    v_dot2c_f32_bf16 v40, v82, v19
    v_dot2c_f32_bf16 v41, v82, v58
    v_dot2c_f32_bf16 v42, v83, v19
    v_dot2c_f32_bf16 v43, v83, v58
    v_dot2c_f32_bf16 v44, v84, v19
    v_dot2c_f32_bf16 v45, v84, v58
    v_dot2c_f32_bf16 v46, v85, v19
    v_dot2c_f32_bf16 v47, v85, v58
    v_dot2c_f32_bf16 v48, v86, v19
    v_dot2c_f32_bf16 v49, v86, v58
    v_dot2c_f32_bf16 v50, v87, v19
    v_dot2c_f32_bf16 v51, v87, v58
    v_lshlrev_b32 v58, 16, v20
    s_waitcnt vmcnt(15)
    v_dot2c_f32_bf16 v28, v88, v20
    v_dot2c_f32_bf16 v29, v88, v58
    v_dot2c_f32_bf16 v30, v89, v20
    v_dot2c_f32_bf16 v31, v89, v58
    v_dot2c_f32_bf16 v32, v90, v20
    v_dot2c_f32_bf16 v33, v90, v58
    v_dot2c_f32_bf16 v34, v91, v20
    v_dot2c_f32_bf16 v35, v91, v58
    v_dot2c_f32_bf16 v36, v92, v20
    v_dot2c_f32_bf16 v37, v92, v58
    v_dot2c_f32_bf16 v38, v93, v20
    v_dot2c_f32_bf16 v39, v93, v58
    v_dot2c_f32_bf16 v40, v94, v20
    v_dot2c_f32_bf16 v41, v94, v58
    v_dot2c_f32_bf16 v42, v95, v20
    v_dot2c_f32_bf16 v43, v95, v58
    v_dot2c_f32_bf16 v44, v96, v20
    v_dot2c_f32_bf16 v45, v96, v58
    v_dot2c_f32_bf16 v46, v97, v20
    v_dot2c_f32_bf16 v47, v97, v58
    v_dot2c_f32_bf16 v48, v98, v20
    v_dot2c_f32_bf16 v49, v98, v58
    v_dot2c_f32_bf16 v50, v99, v20
    v_dot2c_f32_bf16 v51, v99, v58
    v_lshlrev_b32 v58, 16, v21
    s_waitcnt vmcnt(12)
    v_dot2c_f32_bf16 v28, v100, v21
    v_dot2c_f32_bf16 v29, v100, v58
    v_dot2c_f32_bf16 v30, v101, v21
    v_dot2c_f32_bf16 v31, v101, v58
    v_dot2c_f32_bf16 v32, v102, v21
    v_dot2c_f32_bf16 v33, v102, v58
    v_dot2c_f32_bf16 v34, v103, v21
    v_dot2c_f32_bf16 v35, v103, v58
    v_dot2c_f32_bf16 v36, v104, v21
    v_dot2c_f32_bf16 v37, v104, v58
    v_dot2c_f32_bf16 v38, v105, v21
    v_dot2c_f32_bf16 v39, v105, v58
    v_dot2c_f32_bf16 v40, v106, v21
    v_dot2c_f32_bf16 v41, v106, v58
    v_dot2c_f32_bf16 v42, v107, v21
    v_dot2c_f32_bf16 v43, v107, v58
    v_dot2c_f32_bf16 v44, v108, v21
    v_dot2c_f32_bf16 v45, v108, v58
    v_dot2c_f32_bf16 v46, v109, v21
    v_dot2c_f32_bf16 v47, v109, v58
    v_dot2c_f32_bf16 v48, v110, v21
    v_dot2c_f32_bf16 v49, v110, v58
    v_dot2c_f32_bf16 v50, v111, v21
    v_dot2c_f32_bf16 v51, v111, v58
    v_lshlrev_b32 v58, 16, v22
    s_waitcnt vmcnt(9)
    v_dot2c_f32_bf16 v28, v112, v22
    v_dot2c_f32_bf16 v29, v112, v58
    v_dot2c_f32_bf16 v30, v113, v22
    v_dot2c_f32_bf16 v31, v113, v58
    v_dot2c_f32_bf16 v32, v114, v22
    v_dot2c_f32_bf16 v33, v114, v58
    v_dot2c_f32_bf16 v34, v115, v22
    v_dot2c_f32_bf16 v35, v115, v58
    v_dot2c_f32_bf16 v36, v116, v22
    v_dot2c_f32_bf16 v37, v116, v58
    v_dot2c_f32_bf16 v38, v117, v22
    v_dot2c_f32_bf16 v39, v117, v58
    v_dot2c_f32_bf16 v40, v118, v22
    v_dot2c_f32_bf16 v41, v118, v58
    v_dot2c_f32_bf16 v42, v119, v22
    v_dot2c_f32_bf16 v43, v119, v58
    v_dot2c_f32_bf16 v44, v120, v22
    v_dot2c_f32_bf16 v45, v120, v58
    v_dot2c_f32_bf16 v46, v121, v22
    v_dot2c_f32_bf16 v47, v121, v58
    v_dot2c_f32_bf16 v48, v122, v22
    v_dot2c_f32_bf16 v49, v122, v58
    v_dot2c_f32_bf16 v50, v123, v22
    v_dot2c_f32_bf16 v51, v123, v58
    v_lshlrev_b32 v58, 16, v23
    s_waitcnt vmcnt(6)
    v_dot2c_f32_bf16 v28, v124, v23
    v_dot2c_f32_bf16 v29, v124, v58
    v_dot2c_f32_bf16 v30, v125, v23
    v_dot2c_f32_bf16 v31, v125, v58
    v_dot2c_f32_bf16 v32, v126, v23
    v_dot2c_f32_bf16 v33, v126, v58
    v_dot2c_f32_bf16 v34, v127, v23
    v_dot2c_f32_bf16 v35, v127, v58
    v_dot2c_f32_bf16 v36, v128, v23
    v_dot2c_f32_bf16 v37, v128, v58
    v_dot2c_f32_bf16 v38, v129, v23
    v_dot2c_f32_bf16 v39, v129, v58
    v_dot2c_f32_bf16 v40, v130, v23
    v_dot2c_f32_bf16 v41, v130, v58
    v_dot2c_f32_bf16 v42, v131, v23
    v_dot2c_f32_bf16 v43, v131, v58
    v_dot2c_f32_bf16 v44, v132, v23
    v_dot2c_f32_bf16 v45, v132, v58
    v_dot2c_f32_bf16 v46, v133, v23
    v_dot2c_f32_bf16 v47, v133, v58
    v_dot2c_f32_bf16 v48, v134, v23
    v_dot2c_f32_bf16 v49, v134, v58
    v_dot2c_f32_bf16 v50, v135, v23
    v_dot2c_f32_bf16 v51, v135, v58
    v_lshlrev_b32 v58, 16, v24
    s_waitcnt vmcnt(3)
    v_dot2c_f32_bf16 v28, v136, v24
    v_dot2c_f32_bf16 v29, v136, v58
    v_dot2c_f32_bf16 v30, v137, v24
    v_dot2c_f32_bf16 v31, v137, v58
    v_dot2c_f32_bf16 v32, v138, v24
    v_dot2c_f32_bf16 v33, v138, v58
    v_dot2c_f32_bf16 v34, v139, v24
    v_dot2c_f32_bf16 v35, v139, v58
    v_dot2c_f32_bf16 v36, v140, v24
    v_dot2c_f32_bf16 v37, v140, v58
    v_dot2c_f32_bf16 v38, v141, v24
    v_dot2c_f32_bf16 v39, v141, v58
    v_dot2c_f32_bf16 v40, v142, v24
    v_dot2c_f32_bf16 v41, v142, v58
    v_dot2c_f32_bf16 v42, v143, v24
    v_dot2c_f32_bf16 v43, v143, v58
    v_dot2c_f32_bf16 v44, v144, v24
    v_dot2c_f32_bf16 v45, v144, v58
    v_dot2c_f32_bf16 v46, v145, v24
    v_dot2c_f32_bf16 v47, v145, v58
    v_dot2c_f32_bf16 v48, v146, v24
    v_dot2c_f32_bf16 v49, v146, v58
    v_dot2c_f32_bf16 v50, v147, v24
    v_dot2c_f32_bf16 v51, v147, v58
    v_lshlrev_b32 v58, 16, v25
    s_waitcnt vmcnt(0)
    v_dot2c_f32_bf16 v28, v148, v25
    v_dot2c_f32_bf16 v29, v148, v58
    v_dot2c_f32_bf16 v30, v149, v25
    v_dot2c_f32_bf16 v31, v149, v58
    v_dot2c_f32_bf16 v32, v150, v25
    v_dot2c_f32_bf16 v33, v150, v58
    v_dot2c_f32_bf16 v34, v151, v25
    v_dot2c_f32_bf16 v35, v151, v58
    v_dot2c_f32_bf16 v36, v152, v25
    v_dot2c_f32_bf16 v37, v152, v58
    v_dot2c_f32_bf16 v38, v153, v25
    v_dot2c_f32_bf16 v39, v153, v58
    v_dot2c_f32_bf16 v40, v154, v25
    v_dot2c_f32_bf16 v41, v154, v58
    v_dot2c_f32_bf16 v42, v155, v25
    v_dot2c_f32_bf16 v43, v155, v58
    v_dot2c_f32_bf16 v44, v156, v25
    v_dot2c_f32_bf16 v45, v156, v58
    v_dot2c_f32_bf16 v46, v157, v25
    v_dot2c_f32_bf16 v47, v157, v58
    v_dot2c_f32_bf16 v48, v158, v25
    v_dot2c_f32_bf16 v49, v158, v58
    v_dot2c_f32_bf16 v50, v159, v25
    v_dot2c_f32_bf16 v51, v159, v58
    v_add_f32_dpp v28, v28, v28 row_ror:8 row_mask:0xf bank_mask:0xf
    v_add_f32_dpp v29, v29, v29 row_ror:8 row_mask:0xf bank_mask:0xf
    v_add_f32_dpp v30, v30, v30 row_ror:8 row_mask:0xf bank_mask:0xf
    v_add_f32_dpp v31, v31, v31 row_ror:8 row_mask:0xf bank_mask:0xf
    v_add_f32_dpp v32, v32, v32 row_ror:8 row_mask:0xf bank_mask:0xf
    v_add_f32_dpp v33, v33, v33 row_ror:8 row_mask:0xf bank_mask:0xf
    v_add_f32_dpp v34, v34, v34 row_ror:8 row_mask:0xf bank_mask:0xf
    v_add_f32_dpp v35, v35, v35 row_ror:8 row_mask:0xf bank_mask:0xf
    v_add_f32_dpp v36, v36, v36 row_ror:8 row_mask:0xf bank_mask:0xf
    v_add_f32_dpp v37, v37, v37 row_ror:8 row_mask:0xf bank_mask:0xf
    v_add_f32_dpp v38, v38, v38 row_ror:8 row_mask:0xf bank_mask:0xf
    v_add_f32_dpp v39, v39, v39 row_ror:8 row_mask:0xf bank_mask:0xf
    v_add_f32_dpp v40, v40, v40 row_ror:8 row_mask:0xf bank_mask:0xf
    v_add_f32_dpp v41, v41, v41 row_ror:8 row_mask:0xf bank_mask:0xf
    v_add_f32_dpp v42, v42, v42 row_ror:8 row_mask:0xf bank_mask:0xf
    v_add_f32_dpp v43, v43, v43 row_ror:8 row_mask:0xf bank_mask:0xf
    v_add_f32_dpp v44, v44, v44 row_ror:8 row_mask:0xf bank_mask:0xf
    v_add_f32_dpp v45, v45, v45 row_ror:8 row_mask:0xf bank_mask:0xf
    v_add_f32_dpp v46, v46, v46 row_ror:8 row_mask:0xf bank_mask:0xf
    v_add_f32_dpp v47, v47, v47 row_ror:8 row_mask:0xf bank_mask:0xf
    v_add_f32_dpp v48, v48, v48 row_ror:8 row_mask:0xf bank_mask:0xf
    v_add_f32_dpp v49, v49, v49 row_ror:8 row_mask:0xf bank_mask:0xf
    v_add_f32_dpp v50, v50, v50 row_ror:8 row_mask:0xf bank_mask:0xf
    v_add_f32_dpp v51, v51, v51 row_ror:8 row_mask:0xf bank_mask:0xf
    v_lshrrev_b32 v8, 4, v1
    s_lshl_b32 s59, s3, 2
    v_add_u32 v8, s59, v8
    v_mul_u32_u24 v8, 768, v8
    v_lshlrev_b32 v9, 5, v4
    v_add_u32 v8, v8, v9
    s_mov_b32 exec_lo, 0x00ff00ff
    s_mov_b32 exec_hi, 0x00ff00ff
    ds_write_b128 v8, v[28:31] offset:2048
    ds_write_b128 v8, v[32:35] offset:2064
    ds_write_b128 v8, v[36:39] offset:2304
    ds_write_b128 v8, v[40:43] offset:2320
    ds_write_b128 v8, v[44:47] offset:2560
    ds_write_b128 v8, v[48:51] offset:2576
    s_mov_b64 exec, -1
    s_waitcnt lgkmcnt(0)
    v_mov_b32 v8, 0
    v_mov_b32 v9, 1
    s_mov_b64 exec, 1
    ds_add_u32 v8, v9 offset:1972
    s_mov_b64 exec, -1
    s_cmp_ge_u32 s3, 4
    s_cbranch_scc1 L_helper_8
    v_mov_b32 v8, 0
L_spin_9:
    ds_read_b32 v9, v8 offset:1968
    s_waitcnt lgkmcnt(0)
    v_readfirstlane_b32 s59, v9
    s_nop 0
    s_cmp_lt_u32 s59, 4
    s_cbranch_scc1 L_spin_9
    s_and_b32 s57, s57, 511
    s_lshr_b32 s59, s57, 6
    s_and_b32 s60, s57, 63
    s_mul_i32 s59, s59, 196608
    s_mul_i32 s60, s60, 1536
    s_add_u32 s59, s59, s60
    s_add_u32 s62, s59, s56
    buffer_load_dwordx4 v[184:187], v12, s[32:35], s62 offen offset:0 nt
    buffer_load_dwordx4 v[188:191], v12, s[32:35], s62 offen offset:128 nt
    buffer_load_dwordx4 v[192:195], v12, s[32:35], s62 offen offset:256 nt
    s_add_u32 s57, s57, 4
    s_and_b32 s58, s58, 511
    s_lshr_b32 s59, s58, 6
    s_and_b32 s60, s58, 63
    s_mul_i32 s59, s59, 196608
    s_mul_i32 s60, s60, 1536
    s_add_u32 s59, s59, s60
    s_add_u32 s62, s59, s56
    buffer_load_dwordx4 v[196:199], v12, s[36:39], s62 offen offset:0 nt
    buffer_load_dwordx4 v[200:203], v12, s[36:39], s62 offen offset:128 nt
    buffer_load_dwordx4 v[204:207], v12, s[36:39], s62 offen offset:256 nt
    s_add_u32 s58, s58, 4
    s_and_b32 s57, s57, 511
    s_lshr_b32 s59, s57, 6
    s_and_b32 s60, s57, 63
    s_mul_i32 s59, s59, 196608
    s_mul_i32 s60, s60, 1536
    s_add_u32 s59, s59, s60
    s_add_u32 s62, s59, s56
    buffer_load_dwordx4 v[208:211], v12, s[32:35], s62 offen offset:0 nt
    buffer_load_dwordx4 v[212:215], v12, s[32:35], s62 offen offset:128 nt
    buffer_load_dwordx4 v[216:219], v12, s[32:35], s62 offen offset:256 nt
    s_add_u32 s57, s57, 4
    s_and_b32 s58, s58, 511
    s_lshr_b32 s59, s58, 6
    s_and_b32 s60, s58, 63
    s_mul_i32 s59, s59, 196608
    s_mul_i32 s60, s60, 1536
    s_add_u32 s59, s59, s60
    s_add_u32 s62, s59, s56
    buffer_load_dwordx4 v[220:223], v12, s[36:39], s62 offen offset:0 nt
    buffer_load_dwordx4 v[224:227], v12, s[36:39], s62 offen offset:128 nt
    buffer_load_dwordx4 v[228:231], v12, s[36:39], s62 offen offset:256 nt
    s_add_u32 s58, s58, 4
    s_and_b32 s57, s57, 511
    s_lshr_b32 s59, s57, 6
    s_and_b32 s60, s57, 63
    s_mul_i32 s59, s59, 196608
    s_mul_i32 s60, s60, 1536
    s_add_u32 s59, s59, s60
    s_add_u32 s62, s59, s56
    buffer_load_dwordx4 v[232:235], v12, s[32:35], s62 offen offset:0 nt
    buffer_load_dwordx4 v[236:239], v12, s[32:35], s62 offen offset:128 nt
    buffer_load_dwordx4 v[240:243], v12, s[32:35], s62 offen offset:256 nt
    s_add_u32 s57, s57, 4
    s_and_b32 s58, s58, 511
    s_lshr_b32 s59, s58, 6
    s_and_b32 s60, s58, 63
    s_mul_i32 s59, s59, 196608
    s_mul_i32 s60, s60, 1536
    s_add_u32 s59, s59, s60
    s_add_u32 s62, s59, s56
    buffer_load_dwordx4 v[244:247], v12, s[36:39], s62 offen offset:0 nt
    buffer_load_dwordx4 v[248:251], v12, s[36:39], s62 offen offset:128 nt
    buffer_load_dwordx4 v[252:255], v12, s[36:39], s62 offen offset:256 nt
    s_add_u32 s58, s58, 4
    s_and_b32 s57, s57, 511
    s_lshr_b32 s59, s57, 6
    s_and_b32 s60, s57, 63
    s_mul_i32 s59, s59, 196608
    s_mul_i32 s60, s60, 1536
    s_add_u32 s59, s59, s60
    s_add_u32 s62, s59, s56
    buffer_load_dwordx4 v[160:163], v12, s[32:35], s62 offen offset:0 nt
    buffer_load_dwordx4 v[164:167], v12, s[32:35], s62 offen offset:128 nt
    buffer_load_dwordx4 v[168:171], v12, s[32:35], s62 offen offset:256 nt
    s_add_u32 s57, s57, 4
    s_and_b32 s58, s58, 511
    s_lshr_b32 s59, s58, 6
    s_and_b32 s60, s58, 63
    s_mul_i32 s59, s59, 196608
    s_mul_i32 s60, s60, 1536
    s_add_u32 s59, s59, s60
    s_add_u32 s62, s59, s56
    buffer_load_dwordx4 v[172:175], v12, s[36:39], s62 offen offset:0 nt
    buffer_load_dwordx4 v[176:179], v12, s[36:39], s62 offen offset:128 nt
    buffer_load_dwordx4 v[180:183], v12, s[36:39], s62 offen offset:256 nt
    s_add_u32 s58, s58, 4
    s_branch L_noqa_7
L_helper_8:
    s_cmp_ge_u32 s3, 7
    s_cbranch_scc1 L_noqa_7
    v_mov_b32 v8, 0
L_spin_10:
    ds_read_b32 v9, v8 offset:1972
    s_waitcnt lgkmcnt(0)
    v_readfirstlane_b32 s59, v9
    s_nop 0
    s_cmp_lt_u32 s59, 8
    s_cbranch_scc1 L_spin_10
    v_subrev_u32 v10, 256, v0
    v_lshlrev_b32 v8, 2, v10
    ds_read_b32 v28, v8 offset:2048
    ds_read_b32 v29, v8 offset:2816
    ds_read_b32 v30, v8 offset:3584
    ds_read_b32 v31, v8 offset:4352
    ds_read_b32 v32, v8 offset:5120
    ds_read_b32 v33, v8 offset:5888
    ds_read_b32 v34, v8 offset:6656
    ds_read_b32 v35, v8 offset:7424
    ds_read_b32 v36, v8 offset:8192
    ds_read_b32 v37, v8 offset:8960
    ds_read_b32 v38, v8 offset:9728
    ds_read_b32 v39, v8 offset:10496
    ds_read_b32 v40, v8 offset:11264
    ds_read_b32 v41, v8 offset:12032
    ds_read_b32 v42, v8 offset:12800
    ds_read_b32 v43, v8 offset:13568
    ds_read_b32 v64, v8 offset:14336
    ds_read_b32 v65, v8 offset:15104
    ds_read_b32 v66, v8 offset:15872
    ds_read_b32 v67, v8 offset:16640
    ds_read_b32 v68, v8 offset:17408
    ds_read_b32 v69, v8 offset:18176
    ds_read_b32 v70, v8 offset:18944
    ds_read_b32 v71, v8 offset:19712
    ds_read_b32 v72, v8 offset:20480
    ds_read_b32 v73, v8 offset:21248
    ds_read_b32 v74, v8 offset:22016
    ds_read_b32 v75, v8 offset:22784
    ds_read_b32 v76, v8 offset:23552
    ds_read_b32 v77, v8 offset:24320
    ds_read_b32 v78, v8 offset:25088
    ds_read_b32 v79, v8 offset:25856
    s_waitcnt lgkmcnt(8)
    v_add_f32 v28, v28, v36
    v_add_f32 v29, v29, v37
    v_add_f32 v30, v30, v38
    v_add_f32 v31, v31, v39
    v_add_f32 v32, v32, v40
    v_add_f32 v33, v33, v41
    v_add_f32 v34, v34, v42
    v_add_f32 v35, v35, v43
    s_waitcnt lgkmcnt(0)
    v_add_f32 v28, v28, v64
    v_add_f32 v29, v29, v65
    v_add_f32 v30, v30, v66
    v_add_f32 v31, v31, v67
    v_add_f32 v32, v32, v68
    v_add_f32 v33, v33, v69
    v_add_f32 v34, v34, v70
    v_add_f32 v35, v35, v71
    v_add_f32 v28, v28, v72
    v_add_f32 v29, v29, v73
    v_add_f32 v30, v30, v74
    v_add_f32 v31, v31, v75
    v_add_f32 v32, v32, v76
    v_add_f32 v33, v33, v77
    v_add_f32 v34, v34, v78
    v_add_f32 v35, v35, v79
    v_add_f32 v28, v28, v32
    v_add_f32 v29, v29, v33
    v_add_f32 v30, v30, v34
    v_add_f32 v31, v31, v35
    v_add_f32 v28, v28, v30
    v_add_f32 v29, v29, v31
    v_add_f32 v28, v28, v29
    v_cvt_pk_bf16_f32 v57, v28, v28
    v_lshlrev_b32 v8, 1, v10
    ds_write_b16 v8, v57 offset:1280
    s_waitcnt lgkmcnt(0)
    v_mov_b32 v8, 0
    v_mov_b32 v9, 1
    s_mov_b64 exec, 1
    ds_add_u32 v8, v9 offset:1976
    s_mov_b64 exec, -1
L_noqa_7:
    v_mov_b32 v8, 0
L_spin_11:
    ds_read_b32 v9, v8 offset:1976
    s_waitcnt lgkmcnt(0)
    v_readfirstlane_b32 s59, v9
    s_nop 0
    s_cmp_lt_u32 s59, 3
    s_cbranch_scc1 L_spin_11
    s_cmp_ge_u32 s3, 4
    s_cbranch_scc1 L_aux
    s_mov_b32 s12, s0
    v_lshlrev_b32 v8, 4, v4
    ds_read_b128 v[16:19], v8 offset:1280
    ds_read_b128 v[20:23], v8 offset:1408
    ds_read_b128 v[24:27], v8 offset:1536
    v_mov_b32 v28, 0
    v_mov_b32 v29, 0
    v_mov_b32 v30, 0
    v_mov_b32 v31, 0
    v_mov_b32 v32, 0
    v_mov_b32 v33, 0
    v_mov_b32 v34, 0
    v_mov_b32 v35, 0
    v_mov_b32 v36, 0
    v_mov_b32 v37, 0
    v_mov_b32 v38, 0
    v_mov_b32 v39, 0
    v_mov_b32 v40, 0
    v_mov_b32 v41, 0
    v_mov_b32 v42, 0
    v_mov_b32 v43, 0
    v_mov_b32 v44, 0
    v_mov_b32 v45, 0
    v_mov_b32 v46, 0
    v_mov_b32 v47, 0
    v_mov_b32 v48, 0
    v_mov_b32 v49, 0
    v_mov_b32 v50, 0
    v_mov_b32 v51, 0
    v_mov_b32 v52, 0xff800000
    v_mov_b32 v54, 0xff800000
    v_mov_b32 v53, 0
    v_and_b32 v9, 15, v1
    v_mul_u32_u24 v5, 784, v9
    v_lshrrev_b32 v11, 4, v1
    v_mul_u32_u24 v11, 16, v11
    v_add_u32 v5, v5, v11
    s_lshl_b32 s59, s3, 6
    v_add_u32 v5, s59, v5
    v_lshrrev_b32 v6, 2, v9
    v_lshlrev_b32 v6, 3, v6
    s_mul_i32 s59, s3, 20480
    v_lshlrev_b32 v7, 4, v1
    v_add_u32 v7, s59, v7
    v_add_u32 v7, 37120, v7
    s_mov_b32 s63, 0
    s_waitcnt lgkmcnt(0)
    s_mov_b32 s26, 7
    s_mov_b32 s27, 0
    s_mov_b32 s13, 2
    s_mov_b32 s14, s13
    v_mov_b32 v14, 0
L_loop_12:
    s_memrealtime s[10:11]
    ds_read_b64 v[10:11], v14 offset:2016
    s_sub_u32 s59, s26, s27
    s_cmp_gt_u32 s59, 1
    s_cbranch_scc1 L_w6_13
    s_waitcnt vmcnt(3)
    s_branch L_wd_14
L_w6_13:
    s_waitcnt vmcnt(6)
L_wd_14:
    v_mov_b32 v55, 0
    v_dot2c_f32_bf16 v55, v184, v16
    v_dot2c_f32_bf16 v55, v185, v17
    v_dot2c_f32_bf16 v55, v186, v18
    v_dot2c_f32_bf16 v55, v187, v19
    v_dot2c_f32_bf16 v55, v188, v20
    v_dot2c_f32_bf16 v55, v189, v21
    v_dot2c_f32_bf16 v55, v190, v22
    v_dot2c_f32_bf16 v55, v191, v23
    v_dot2c_f32_bf16 v55, v192, v24
    v_dot2c_f32_bf16 v55, v193, v25
    v_dot2c_f32_bf16 v55, v194, v26
    v_dot2c_f32_bf16 v55, v195, v27
    s_sub_u32 s61, s26, s27
    s_cmp_eq_u32 s61, 1
    s_cbranch_scc0 L_skipA_15
    s_and_b32 s57, s57, 511
    s_lshr_b32 s59, s57, 6
    s_and_b32 s60, s57, 63
    s_mul_i32 s59, s59, 196608
    s_mul_i32 s60, s60, 1536
    s_add_u32 s59, s59, s60
    s_add_u32 s62, s59, s56
    buffer_load_dwordx4 v[208:211], v12, s[32:35], s62 offen offset:0 nt
    buffer_load_dwordx4 v[212:215], v12, s[32:35], s62 offen offset:128 nt
    buffer_load_dwordx4 v[216:219], v12, s[32:35], s62 offen offset:256 nt
    s_add_u32 s57, s57, 4
    s_add_u32 s26, s26, 1
L_skipA_15:
    s_cmp_eq_u32 s14, 3
    s_cbranch_scc0 L_skipB_16
    s_sub_u32 s61, s26, s27
    s_cmp_eq_u32 s61, 2
    s_cbranch_scc0 L_skipB_16
    s_and_b32 s58, s58, 511
    s_lshr_b32 s59, s58, 6
    s_and_b32 s60, s58, 63
    s_mul_i32 s59, s59, 196608
    s_mul_i32 s60, s60, 1536
    s_add_u32 s59, s59, s60
    s_add_u32 s62, s59, s56
    buffer_load_dwordx4 v[220:223], v12, s[36:39], s62 offen offset:0 nt
    buffer_load_dwordx4 v[224:227], v12, s[36:39], s62 offen offset:128 nt
    buffer_load_dwordx4 v[228:231], v12, s[36:39], s62 offen offset:256 nt
    s_add_u32 s58, s58, 4
    s_add_u32 s26, s26, 1
L_skipB_16:
    s_waitcnt lgkmcnt(0)
    v_readfirstlane_b32 s15, v10
    v_readfirstlane_b32 s19, v11
    s_add_u32 s18, s27, 0
    s_lshr_b32 s18, s18, 1
    s_cmp_lg_u32 s18, 8
    s_cbranch_scc1 L_nostamp_17
    v_mov_b32 v13, s10
    ds_write_b32 v14, v13 offset:2024
L_nostamp_17:
    s_cmp_lg_u32 s18, 36
    s_cbranch_scc1 L_nostamp_18
    v_mov_b32 v13, s10
    ds_write_b32 v14, v13 offset:2028
L_nostamp_18:
    s_cmp_lg_u32 s18, 84
    s_cbranch_scc1 L_nostamp_19
    v_mov_b32 v13, s10
    ds_write_b32 v14, v13 offset:2032
L_nostamp_19:
    s_sub_u32 s18, s18, 36
    s_mul_i32 s18, s18, s19
    s_sub_u32 s61, s10, s15
    s_lshl_b32 s61, s61, 4
    s_cmp_gt_i32 s61, s18
    s_cselect_b32 s14, 3, 2
    s_cmp_eq_u32 s19, 0
    s_cselect_b32 s14, s13, s14
    v_add_f32_dpp v55, v55, v55 quad_perm:[1,0,3,2] row_mask:0xf bank_mask:0xf
    s_nop 1
    v_add_f32_dpp v55, v55, v55 quad_perm:[2,3,0,1] row_mask:0xf bank_mask:0xf
    s_nop 1
    v_add_f32_dpp v55, v55, v55 row_half_mirror row_mask:0xf bank_mask:0xf
    v_cmp_gt_f32 vcc, v55, v52
    s_nop 0
    s_cbranch_vccz L_nors_20
    v_max_f32 v59, v55, v52
    v_sub_f32 v60, v52, v59
    v_mul_f32 v60, s64, v60
    v_exp_f32 v60, v60
    v_mov_b32 v52, v59
    v_mul_f32 v54, s64, v59
    v_mul_f32 v53, v53, v60
    v_mul_f32 v28, v28, v60
    v_mul_f32 v29, v29, v60
    v_mul_f32 v30, v30, v60
    v_mul_f32 v31, v31, v60
    v_mul_f32 v32, v32, v60
    v_mul_f32 v33, v33, v60
    v_mul_f32 v34, v34, v60
    v_mul_f32 v35, v35, v60
    v_mul_f32 v36, v36, v60
    v_mul_f32 v37, v37, v60
    v_mul_f32 v38, v38, v60
    v_mul_f32 v39, v39, v60
    v_mul_f32 v40, v40, v60
    v_mul_f32 v41, v41, v60
    v_mul_f32 v42, v42, v60
    v_mul_f32 v43, v43, v60
    v_mul_f32 v44, v44, v60
    v_mul_f32 v45, v45, v60
    v_mul_f32 v46, v46, v60
    v_mul_f32 v47, v47, v60
    v_mul_f32 v48, v48, v60
    v_mul_f32 v49, v49, v60
    v_mul_f32 v50, v50, v60
    v_mul_f32 v51, v51, v60
L_nors_20:
    v_fma_f32 v56, v55, s64, -v54
    v_exp_f32 v56, v56
    s_nop 0
    v_cvt_pk_bf16_f32 v57, v56, 0
    v_lshlrev_b32 v58, 16, v57
    v_add_f32 v53, v53, v58
    s_sub_u32 s59, s26, s27
    s_cmp_gt_u32 s59, 2
    s_cbranch_scc1 L_w6_21
    s_waitcnt vmcnt(3)
    s_branch L_wd_22
L_w6_21:
    s_waitcnt vmcnt(6)
L_wd_22:
    v_dot2c_f32_bf16 v28, v196, v57
    v_dot2c_f32_bf16 v29, v196, v58
    v_dot2c_f32_bf16 v30, v197, v57
    v_dot2c_f32_bf16 v31, v197, v58
    v_dot2c_f32_bf16 v32, v198, v57
    v_dot2c_f32_bf16 v33, v198, v58
    v_dot2c_f32_bf16 v34, v199, v57
    v_dot2c_f32_bf16 v35, v199, v58
    v_dot2c_f32_bf16 v36, v200, v57
    v_dot2c_f32_bf16 v37, v200, v58
    v_dot2c_f32_bf16 v38, v201, v57
    v_dot2c_f32_bf16 v39, v201, v58
    v_dot2c_f32_bf16 v40, v202, v57
    v_dot2c_f32_bf16 v41, v202, v58
    v_dot2c_f32_bf16 v42, v203, v57
    v_dot2c_f32_bf16 v43, v203, v58
    v_dot2c_f32_bf16 v44, v204, v57
    v_dot2c_f32_bf16 v45, v204, v58
    v_dot2c_f32_bf16 v46, v205, v57
    v_dot2c_f32_bf16 v47, v205, v58
    v_dot2c_f32_bf16 v48, v206, v57
    v_dot2c_f32_bf16 v49, v206, v58
    v_dot2c_f32_bf16 v50, v207, v57
    v_dot2c_f32_bf16 v51, v207, v58
    s_sub_u32 s61, s26, s27
    s_cmp_eq_u32 s61, 2
    s_cbranch_scc0 L_skipA_23
    s_and_b32 s58, s58, 511
    s_lshr_b32 s59, s58, 6
    s_and_b32 s60, s58, 63
    s_mul_i32 s59, s59, 196608
    s_mul_i32 s60, s60, 1536
    s_add_u32 s59, s59, s60
    s_add_u32 s62, s59, s56
    buffer_load_dwordx4 v[220:223], v12, s[36:39], s62 offen offset:0 nt
    buffer_load_dwordx4 v[224:227], v12, s[36:39], s62 offen offset:128 nt
    buffer_load_dwordx4 v[228:231], v12, s[36:39], s62 offen offset:256 nt
    s_add_u32 s58, s58, 4
    s_add_u32 s26, s26, 1
L_skipA_23:
    s_cmp_eq_u32 s14, 3
    s_cbranch_scc0 L_skipB_24
    s_sub_u32 s61, s26, s27
    s_cmp_eq_u32 s61, 3
    s_cbranch_scc0 L_skipB_24
    s_and_b32 s57, s57, 511
    s_lshr_b32 s59, s57, 6
    s_and_b32 s60, s57, 63
    s_mul_i32 s59, s59, 196608
    s_mul_i32 s60, s60, 1536
    s_add_u32 s59, s59, s60
    s_add_u32 s62, s59, s56
    buffer_load_dwordx4 v[232:235], v12, s[32:35], s62 offen offset:0 nt
    buffer_load_dwordx4 v[236:239], v12, s[32:35], s62 offen offset:128 nt
    buffer_load_dwordx4 v[240:243], v12, s[32:35], s62 offen offset:256 nt
    s_add_u32 s57, s57, 4
    s_add_u32 s26, s26, 1
L_skipB_24:
    s_add_u32 s60, s27, 2
    s_lshr_b32 s60, s60, 1
    v_mov_b32 v13, s60
    ds_write_b32 v14, v13 offset:2000
    s_memrealtime s[10:11]
    ds_read_b64 v[10:11], v14 offset:2016
    s_sub_u32 s59, s26, s27
    s_cmp_gt_u32 s59, 3
    s_cbranch_scc1 L_w6_25
    s_waitcnt vmcnt(3)
    s_branch L_wd_26
L_w6_25:
    s_waitcnt vmcnt(6)
L_wd_26:
    v_mov_b32 v55, 0
    v_dot2c_f32_bf16 v55, v208, v16
    v_dot2c_f32_bf16 v55, v209, v17
    v_dot2c_f32_bf16 v55, v210, v18
    v_dot2c_f32_bf16 v55, v211, v19
    v_dot2c_f32_bf16 v55, v212, v20
    v_dot2c_f32_bf16 v55, v213, v21
    v_dot2c_f32_bf16 v55, v214, v22
    v_dot2c_f32_bf16 v55, v215, v23
    v_dot2c_f32_bf16 v55, v216, v24
    v_dot2c_f32_bf16 v55, v217, v25
    v_dot2c_f32_bf16 v55, v218, v26
    v_dot2c_f32_bf16 v55, v219, v27
    s_sub_u32 s61, s26, s27
    s_cmp_eq_u32 s61, 3
    s_cbranch_scc0 L_skipA_27
    s_and_b32 s57, s57, 511
    s_lshr_b32 s59, s57, 6
    s_and_b32 s60, s57, 63
    s_mul_i32 s59, s59, 196608
    s_mul_i32 s60, s60, 1536
    s_add_u32 s59, s59, s60
    s_add_u32 s62, s59, s56
    buffer_load_dwordx4 v[232:235], v12, s[32:35], s62 offen offset:0 nt
    buffer_load_dwordx4 v[236:239], v12, s[32:35], s62 offen offset:128 nt
    buffer_load_dwordx4 v[240:243], v12, s[32:35], s62 offen offset:256 nt
    s_add_u32 s57, s57, 4
    s_add_u32 s26, s26, 1
L_skipA_27:
    s_cmp_eq_u32 s14, 3
    s_cbranch_scc0 L_skipB_28
    s_sub_u32 s61, s26, s27
    s_cmp_eq_u32 s61, 4
    s_cbranch_scc0 L_skipB_28
    s_and_b32 s58, s58, 511
    s_lshr_b32 s59, s58, 6
    s_and_b32 s60, s58, 63
    s_mul_i32 s59, s59, 196608
    s_mul_i32 s60, s60, 1536
    s_add_u32 s59, s59, s60
    s_add_u32 s62, s59, s56
    buffer_load_dwordx4 v[244:247], v12, s[36:39], s62 offen offset:0 nt
    buffer_load_dwordx4 v[248:251], v12, s[36:39], s62 offen offset:128 nt
    buffer_load_dwordx4 v[252:255], v12, s[36:39], s62 offen offset:256 nt
    s_add_u32 s58, s58, 4
    s_add_u32 s26, s26, 1
L_skipB_28:
    s_waitcnt lgkmcnt(0)
    v_readfirstlane_b32 s15, v10
    v_readfirstlane_b32 s19, v11
    s_add_u32 s18, s27, 2
    s_lshr_b32 s18, s18, 1
    s_sub_u32 s18, s18, 36
    s_mul_i32 s18, s18, s19
    s_sub_u32 s61, s10, s15
    s_lshl_b32 s61, s61, 4
    s_cmp_gt_i32 s61, s18
    s_cselect_b32 s14, 3, 2
    s_cmp_eq_u32 s19, 0
    s_cselect_b32 s14, s13, s14
    v_add_f32_dpp v55, v55, v55 quad_perm:[1,0,3,2] row_mask:0xf bank_mask:0xf
    s_nop 1
    v_add_f32_dpp v55, v55, v55 quad_perm:[2,3,0,1] row_mask:0xf bank_mask:0xf
    s_nop 1
    v_add_f32_dpp v55, v55, v55 row_half_mirror row_mask:0xf bank_mask:0xf
    v_cmp_gt_f32 vcc, v55, v52
    s_nop 0
    s_cbranch_vccz L_nors_29
    v_max_f32 v59, v55, v52
    v_sub_f32 v60, v52, v59
    v_mul_f32 v60, s64, v60
    v_exp_f32 v60, v60
    v_mov_b32 v52, v59
    v_mul_f32 v54, s64, v59
    v_mul_f32 v53, v53, v60
    v_mul_f32 v28, v28, v60
    v_mul_f32 v29, v29, v60
    v_mul_f32 v30, v30, v60
    v_mul_f32 v31, v31, v60
    v_mul_f32 v32, v32, v60
    v_mul_f32 v33, v33, v60
    v_mul_f32 v34, v34, v60
    v_mul_f32 v35, v35, v60
    v_mul_f32 v36, v36, v60
    v_mul_f32 v37, v37, v60
    v_mul_f32 v38, v38, v60
    v_mul_f32 v39, v39, v60
    v_mul_f32 v40, v40, v60
    v_mul_f32 v41, v41, v60
    v_mul_f32 v42, v42, v60
    v_mul_f32 v43, v43, v60
    v_mul_f32 v44, v44, v60
    v_mul_f32 v45, v45, v60
    v_mul_f32 v46, v46, v60
    v_mul_f32 v47, v47, v60
    v_mul_f32 v48, v48, v60
    v_mul_f32 v49, v49, v60
    v_mul_f32 v50, v50, v60
    v_mul_f32 v51, v51, v60
L_nors_29:
    v_fma_f32 v56, v55, s64, -v54
    v_exp_f32 v56, v56
    s_nop 0
    v_cvt_pk_bf16_f32 v57, v56, 0
    v_lshlrev_b32 v58, 16, v57
    v_add_f32 v53, v53, v58
    s_sub_u32 s59, s26, s27
    s_cmp_gt_u32 s59, 4
    s_cbranch_scc1 L_w6_30
    s_waitcnt vmcnt(3)
    s_branch L_wd_31
L_w6_30:
    s_waitcnt vmcnt(6)
L_wd_31:
    v_dot2c_f32_bf16 v28, v220, v57
    v_dot2c_f32_bf16 v29, v220, v58
    v_dot2c_f32_bf16 v30, v221, v57
    v_dot2c_f32_bf16 v31, v221, v58
    v_dot2c_f32_bf16 v32, v222, v57
    v_dot2c_f32_bf16 v33, v222, v58
    v_dot2c_f32_bf16 v34, v223, v57
    v_dot2c_f32_bf16 v35, v223, v58
    v_dot2c_f32_bf16 v36, v224, v57
    v_dot2c_f32_bf16 v37, v224, v58
    v_dot2c_f32_bf16 v38, v225, v57
    v_dot2c_f32_bf16 v39, v225, v58
    v_dot2c_f32_bf16 v40, v226, v57
    v_dot2c_f32_bf16 v41, v226, v58
    v_dot2c_f32_bf16 v42, v227, v57
    v_dot2c_f32_bf16 v43, v227, v58
    v_dot2c_f32_bf16 v44, v228, v57
    v_dot2c_f32_bf16 v45, v228, v58
    v_dot2c_f32_bf16 v46, v229, v57
    v_dot2c_f32_bf16 v47, v229, v58
    v_dot2c_f32_bf16 v48, v230, v57
    v_dot2c_f32_bf16 v49, v230, v58
    v_dot2c_f32_bf16 v50, v231, v57
    v_dot2c_f32_bf16 v51, v231, v58
    s_sub_u32 s61, s26, s27
    s_cmp_eq_u32 s61, 4
    s_cbranch_scc0 L_skipA_32
    s_and_b32 s58, s58, 511
    s_lshr_b32 s59, s58, 6
    s_and_b32 s60, s58, 63
    s_mul_i32 s59, s59, 196608
    s_mul_i32 s60, s60, 1536
    s_add_u32 s59, s59, s60
    s_add_u32 s62, s59, s56
    buffer_load_dwordx4 v[244:247], v12, s[36:39], s62 offen offset:0 nt
    buffer_load_dwordx4 v[248:251], v12, s[36:39], s62 offen offset:128 nt
    buffer_load_dwordx4 v[252:255], v12, s[36:39], s62 offen offset:256 nt
    s_add_u32 s58, s58, 4
    s_add_u32 s26, s26, 1
L_skipA_32:
    s_cmp_eq_u32 s14, 3
    s_cbranch_scc0 L_skipB_33
    s_sub_u32 s61, s26, s27
    s_cmp_eq_u32 s61, 5
    s_cbranch_scc0 L_skipB_33
    s_and_b32 s57, s57, 511
    s_lshr_b32 s59, s57, 6
    s_and_b32 s60, s57, 63
    s_mul_i32 s59, s59, 196608
    s_mul_i32 s60, s60, 1536
    s_add_u32 s59, s59, s60
    s_add_u32 s62, s59, s56
    buffer_load_dwordx4 v[160:163], v12, s[32:35], s62 offen offset:0 nt
    buffer_load_dwordx4 v[164:167], v12, s[32:35], s62 offen offset:128 nt
    buffer_load_dwordx4 v[168:171], v12, s[32:35], s62 offen offset:256 nt
    s_add_u32 s57, s57, 4
    s_add_u32 s26, s26, 1
L_skipB_33:
    s_add_u32 s60, s27, 4
    s_lshr_b32 s60, s60, 1
    v_mov_b32 v13, s60
    ds_write_b32 v14, v13 offset:2000
    s_memrealtime s[10:11]
    ds_read_b64 v[10:11], v14 offset:2016
    s_sub_u32 s59, s26, s27
    s_cmp_gt_u32 s59, 5
    s_cbranch_scc1 L_w6_34
    s_waitcnt vmcnt(3)
    s_branch L_wd_35
L_w6_34:
    s_waitcnt vmcnt(6)
L_wd_35:
    v_mov_b32 v55, 0
    v_dot2c_f32_bf16 v55, v232, v16
    v_dot2c_f32_bf16 v55, v233, v17
    v_dot2c_f32_bf16 v55, v234, v18
    v_dot2c_f32_bf16 v55, v235, v19
    v_dot2c_f32_bf16 v55, v236, v20
    v_dot2c_f32_bf16 v55, v237, v21
    v_dot2c_f32_bf16 v55, v238, v22
    v_dot2c_f32_bf16 v55, v239, v23
    v_dot2c_f32_bf16 v55, v240, v24
    v_dot2c_f32_bf16 v55, v241, v25
    v_dot2c_f32_bf16 v55, v242, v26
    v_dot2c_f32_bf16 v55, v243, v27
    s_sub_u32 s61, s26, s27
    s_cmp_eq_u32 s61, 5
    s_cbranch_scc0 L_skipA_36
    s_and_b32 s57, s57, 511
    s_lshr_b32 s59, s57, 6
    s_and_b32 s60, s57, 63
    s_mul_i32 s59, s59, 196608
    s_mul_i32 s60, s60, 1536
    s_add_u32 s59, s59, s60
    s_add_u32 s62, s59, s56
    buffer_load_dwordx4 v[160:163], v12, s[32:35], s62 offen offset:0 nt
    buffer_load_dwordx4 v[164:167], v12, s[32:35], s62 offen offset:128 nt
    buffer_load_dwordx4 v[168:171], v12, s[32:35], s62 offen offset:256 nt
    s_add_u32 s57, s57, 4
    s_add_u32 s26, s26, 1
L_skipA_36:
    s_cmp_eq_u32 s14, 3
    s_cbranch_scc0 L_skipB_37
    s_sub_u32 s61, s26, s27
    s_cmp_eq_u32 s61, 6
    s_cbranch_scc0 L_skipB_37
    s_and_b32 s58, s58, 511
    s_lshr_b32 s59, s58, 6
    s_and_b32 s60, s58, 63
    s_mul_i32 s59, s59, 196608
    s_mul_i32 s60, s60, 1536
    s_add_u32 s59, s59, s60
    s_add_u32 s62, s59, s56
    buffer_load_dwordx4 v[172:175], v12, s[36:39], s62 offen offset:0 nt
    buffer_load_dwordx4 v[176:179], v12, s[36:39], s62 offen offset:128 nt
    buffer_load_dwordx4 v[180:183], v12, s[36:39], s62 offen offset:256 nt
    s_add_u32 s58, s58, 4
    s_add_u32 s26, s26, 1
L_skipB_37:
    s_waitcnt lgkmcnt(0)
    v_readfirstlane_b32 s15, v10
    v_readfirstlane_b32 s19, v11
    s_add_u32 s18, s27, 4
    s_lshr_b32 s18, s18, 1
    s_sub_u32 s18, s18, 36
    s_mul_i32 s18, s18, s19
    s_sub_u32 s61, s10, s15
    s_lshl_b32 s61, s61, 4
    s_cmp_gt_i32 s61, s18
    s_cselect_b32 s14, 3, 2
    s_cmp_eq_u32 s19, 0
    s_cselect_b32 s14, s13, s14
    v_add_f32_dpp v55, v55, v55 quad_perm:[1,0,3,2] row_mask:0xf bank_mask:0xf
    s_nop 1
    v_add_f32_dpp v55, v55, v55 quad_perm:[2,3,0,1] row_mask:0xf bank_mask:0xf
    s_nop 1
    v_add_f32_dpp v55, v55, v55 row_half_mirror row_mask:0xf bank_mask:0xf
    v_cmp_gt_f32 vcc, v55, v52
    s_nop 0
    s_cbranch_vccz L_nors_38
    v_max_f32 v59, v55, v52
    v_sub_f32 v60, v52, v59
    v_mul_f32 v60, s64, v60
    v_exp_f32 v60, v60
    v_mov_b32 v52, v59
    v_mul_f32 v54, s64, v59
    v_mul_f32 v53, v53, v60
    v_mul_f32 v28, v28, v60
    v_mul_f32 v29, v29, v60
    v_mul_f32 v30, v30, v60
    v_mul_f32 v31, v31, v60
    v_mul_f32 v32, v32, v60
    v_mul_f32 v33, v33, v60
    v_mul_f32 v34, v34, v60
    v_mul_f32 v35, v35, v60
    v_mul_f32 v36, v36, v60
    v_mul_f32 v37, v37, v60
    v_mul_f32 v38, v38, v60
    v_mul_f32 v39, v39, v60
    v_mul_f32 v40, v40, v60
    v_mul_f32 v41, v41, v60
    v_mul_f32 v42, v42, v60
    v_mul_f32 v43, v43, v60
    v_mul_f32 v44, v44, v60
    v_mul_f32 v45, v45, v60
    v_mul_f32 v46, v46, v60
    v_mul_f32 v47, v47, v60
    v_mul_f32 v48, v48, v60
    v_mul_f32 v49, v49, v60
    v_mul_f32 v50, v50, v60
    v_mul_f32 v51, v51, v60
L_nors_38:
    v_fma_f32 v56, v55, s64, -v54
    v_exp_f32 v56, v56
    s_nop 0
    v_cvt_pk_bf16_f32 v57, v56, 0
    v_lshlrev_b32 v58, 16, v57
    v_add_f32 v53, v53, v58
    s_sub_u32 s59, s26, s27
    s_cmp_gt_u32 s59, 6
    s_cbranch_scc1 L_w6_39
    s_waitcnt vmcnt(3)
    s_branch L_wd_40
L_w6_39:
    s_waitcnt vmcnt(6)
L_wd_40:
    v_dot2c_f32_bf16 v28, v244, v57
    v_dot2c_f32_bf16 v29, v244, v58
    v_dot2c_f32_bf16 v30, v245, v57
    v_dot2c_f32_bf16 v31, v245, v58
    v_dot2c_f32_bf16 v32, v246, v57
    v_dot2c_f32_bf16 v33, v246, v58
    v_dot2c_f32_bf16 v34, v247, v57
    v_dot2c_f32_bf16 v35, v247, v58
    v_dot2c_f32_bf16 v36, v248, v57
    v_dot2c_f32_bf16 v37, v248, v58
    v_dot2c_f32_bf16 v38, v249, v57
    v_dot2c_f32_bf16 v39, v249, v58
    v_dot2c_f32_bf16 v40, v250, v57
    v_dot2c_f32_bf16 v41, v250, v58
    v_dot2c_f32_bf16 v42, v251, v57
    v_dot2c_f32_bf16 v43, v251, v58
    v_dot2c_f32_bf16 v44, v252, v57
    v_dot2c_f32_bf16 v45, v252, v58
    v_dot2c_f32_bf16 v46, v253, v57
    v_dot2c_f32_bf16 v47, v253, v58
    v_dot2c_f32_bf16 v48, v254, v57
    v_dot2c_f32_bf16 v49, v254, v58
    v_dot2c_f32_bf16 v50, v255, v57
    v_dot2c_f32_bf16 v51, v255, v58
    s_sub_u32 s61, s26, s27
    s_cmp_eq_u32 s61, 6
    s_cbranch_scc0 L_skipA_41
    s_and_b32 s58, s58, 511
    s_lshr_b32 s59, s58, 6
    s_and_b32 s60, s58, 63
    s_mul_i32 s59, s59, 196608
    s_mul_i32 s60, s60, 1536
    s_add_u32 s59, s59, s60
    s_add_u32 s62, s59, s56
    buffer_load_dwordx4 v[172:175], v12, s[36:39], s62 offen offset:0 nt
    buffer_load_dwordx4 v[176:179], v12, s[36:39], s62 offen offset:128 nt
    buffer_load_dwordx4 v[180:183], v12, s[36:39], s62 offen offset:256 nt
    s_add_u32 s58, s58, 4
    s_add_u32 s26, s26, 1
L_skipA_41:
    s_cmp_eq_u32 s14, 3
    s_cbranch_scc0 L_skipB_42
    s_sub_u32 s61, s26, s27
    s_cmp_eq_u32 s61, 7
    s_cbranch_scc0 L_skipB_42
    s_and_b32 s57, s57, 511
    s_lshr_b32 s59, s57, 6
    s_and_b32 s60, s57, 63
    s_mul_i32 s59, s59, 196608
    s_mul_i32 s60, s60, 1536
    s_add_u32 s59, s59, s60
    s_add_u32 s62, s59, s56
    s_cmp_eq_u32 s63, 31
    s_cselect_b32 s62, 0x80000000, s62
    buffer_load_dwordx4 v[184:187], v12, s[32:35], s62 offen offset:0 nt
    buffer_load_dwordx4 v[188:191], v12, s[32:35], s62 offen offset:128 nt
    buffer_load_dwordx4 v[192:195], v12, s[32:35], s62 offen offset:256 nt
    s_add_u32 s57, s57, 4
    s_add_u32 s26, s26, 1
L_skipB_42:
    s_add_u32 s60, s27, 6
    s_lshr_b32 s60, s60, 1
    v_mov_b32 v13, s60
    ds_write_b32 v14, v13 offset:2000
    s_memrealtime s[10:11]
    ds_read_b64 v[10:11], v14 offset:2016
    s_sub_u32 s59, s26, s27
    s_cmp_gt_u32 s59, 7
    s_cbranch_scc1 L_w6_43
    s_waitcnt vmcnt(3)
    s_branch L_wd_44
L_w6_43:
    s_waitcnt vmcnt(6)
L_wd_44:
    v_mov_b32 v55, 0
    v_dot2c_f32_bf16 v55, v160, v16
    v_dot2c_f32_bf16 v55, v161, v17
    v_dot2c_f32_bf16 v55, v162, v18
    v_dot2c_f32_bf16 v55, v163, v19
    v_dot2c_f32_bf16 v55, v164, v20
    v_dot2c_f32_bf16 v55, v165, v21
    v_dot2c_f32_bf16 v55, v166, v22
    v_dot2c_f32_bf16 v55, v167, v23
    v_dot2c_f32_bf16 v55, v168, v24
    v_dot2c_f32_bf16 v55, v169, v25
    v_dot2c_f32_bf16 v55, v170, v26
    v_dot2c_f32_bf16 v55, v171, v27
    s_sub_u32 s61, s26, s27
    s_cmp_eq_u32 s61, 7
    s_cbranch_scc0 L_skipA_45
    s_and_b32 s57, s57, 511
    s_lshr_b32 s59, s57, 6
    s_and_b32 s60, s57, 63
    s_mul_i32 s59, s59, 196608
    s_mul_i32 s60, s60, 1536
    s_add_u32 s59, s59, s60
    s_add_u32 s62, s59, s56
    s_cmp_eq_u32 s63, 31
    s_cselect_b32 s62, 0x80000000, s62
    buffer_load_dwordx4 v[184:187], v12, s[32:35], s62 offen offset:0 nt
    buffer_load_dwordx4 v[188:191], v12, s[32:35], s62 offen offset:128 nt
    buffer_load_dwordx4 v[192:195], v12, s[32:35], s62 offen offset:256 nt
    s_add_u32 s57, s57, 4
    s_add_u32 s26, s26, 1
L_skipA_45:
    s_cmp_eq_u32 s14, 3
    s_cbranch_scc0 L_skipB_46
    s_sub_u32 s61, s26, s27
    s_cmp_eq_u32 s61, 8
    s_cbranch_scc0 L_skipB_46
    s_and_b32 s58, s58, 511
    s_lshr_b32 s59, s58, 6
    s_and_b32 s60, s58, 63
    s_mul_i32 s59, s59, 196608
    s_mul_i32 s60, s60, 1536
    s_add_u32 s59, s59, s60
    s_add_u32 s62, s59, s56
    s_cmp_eq_u32 s63, 31
    s_cselect_b32 s62, 0x80000000, s62
    buffer_load_dwordx4 v[196:199], v12, s[36:39], s62 offen offset:0 nt
    buffer_load_dwordx4 v[200:203], v12, s[36:39], s62 offen offset:128 nt
    buffer_load_dwordx4 v[204:207], v12, s[36:39], s62 offen offset:256 nt
    s_add_u32 s58, s58, 4
    s_add_u32 s26, s26, 1
L_skipB_46:
    s_waitcnt lgkmcnt(0)
    v_readfirstlane_b32 s15, v10
    v_readfirstlane_b32 s19, v11
    s_add_u32 s18, s27, 6
    s_lshr_b32 s18, s18, 1
    s_sub_u32 s18, s18, 36
    s_mul_i32 s18, s18, s19
    s_sub_u32 s61, s10, s15
    s_lshl_b32 s61, s61, 4
    s_cmp_gt_i32 s61, s18
    s_cselect_b32 s14, 3, 2
    s_cmp_eq_u32 s19, 0
    s_cselect_b32 s14, s13, s14
    v_add_f32_dpp v55, v55, v55 quad_perm:[1,0,3,2] row_mask:0xf bank_mask:0xf
    s_nop 1
    v_add_f32_dpp v55, v55, v55 quad_perm:[2,3,0,1] row_mask:0xf bank_mask:0xf
    s_nop 1
    v_add_f32_dpp v55, v55, v55 row_half_mirror row_mask:0xf bank_mask:0xf
    v_cmp_gt_f32 vcc, v55, v52
    s_nop 0
    s_cbranch_vccz L_nors_47
    v_max_f32 v59, v55, v52
    v_sub_f32 v60, v52, v59
    v_mul_f32 v60, s64, v60
    v_exp_f32 v60, v60
    v_mov_b32 v52, v59
    v_mul_f32 v54, s64, v59
    v_mul_f32 v53, v53, v60
    v_mul_f32 v28, v28, v60
    v_mul_f32 v29, v29, v60
    v_mul_f32 v30, v30, v60
    v_mul_f32 v31, v31, v60
    v_mul_f32 v32, v32, v60
    v_mul_f32 v33, v33, v60
    v_mul_f32 v34, v34, v60
    v_mul_f32 v35, v35, v60
    v_mul_f32 v36, v36, v60
    v_mul_f32 v37, v37, v60
    v_mul_f32 v38, v38, v60
    v_mul_f32 v39, v39, v60
    v_mul_f32 v40, v40, v60
    v_mul_f32 v41, v41, v60
    v_mul_f32 v42, v42, v60
    v_mul_f32 v43, v43, v60
    v_mul_f32 v44, v44, v60
    v_mul_f32 v45, v45, v60
    v_mul_f32 v46, v46, v60
    v_mul_f32 v47, v47, v60
    v_mul_f32 v48, v48, v60
    v_mul_f32 v49, v49, v60
    v_mul_f32 v50, v50, v60
    v_mul_f32 v51, v51, v60
L_nors_47:
    v_fma_f32 v56, v55, s64, -v54
    v_exp_f32 v56, v56
    s_nop 0
    v_cvt_pk_bf16_f32 v57, v56, 0
    v_lshlrev_b32 v58, 16, v57
    v_add_f32 v53, v53, v58
    s_sub_u32 s59, s26, s27
    s_cmp_gt_u32 s59, 8
    s_cbranch_scc1 L_w6_48
    s_waitcnt vmcnt(3)
    s_branch L_wd_49
L_w6_48:
    s_waitcnt vmcnt(6)
L_wd_49:
    v_dot2c_f32_bf16 v28, v172, v57
    v_dot2c_f32_bf16 v29, v172, v58
    v_dot2c_f32_bf16 v30, v173, v57
    v_dot2c_f32_bf16 v31, v173, v58
    v_dot2c_f32_bf16 v32, v174, v57
    v_dot2c_f32_bf16 v33, v174, v58
    v_dot2c_f32_bf16 v34, v175, v57
    v_dot2c_f32_bf16 v35, v175, v58
    v_dot2c_f32_bf16 v36, v176, v57
    v_dot2c_f32_bf16 v37, v176, v58
    v_dot2c_f32_bf16 v38, v177, v57
    v_dot2c_f32_bf16 v39, v177, v58
    v_dot2c_f32_bf16 v40, v178, v57
    v_dot2c_f32_bf16 v41, v178, v58
    v_dot2c_f32_bf16 v42, v179, v57
    v_dot2c_f32_bf16 v43, v179, v58
    v_dot2c_f32_bf16 v44, v180, v57
    v_dot2c_f32_bf16 v45, v180, v58
    v_dot2c_f32_bf16 v46, v181, v57
    v_dot2c_f32_bf16 v47, v181, v58
    v_dot2c_f32_bf16 v48, v182, v57
    v_dot2c_f32_bf16 v49, v182, v58
    v_dot2c_f32_bf16 v50, v183, v57
    v_dot2c_f32_bf16 v51, v183, v58
    s_sub_u32 s61, s26, s27
    s_cmp_eq_u32 s61, 8
    s_cbranch_scc0 L_skipA_50
    s_and_b32 s58, s58, 511
    s_lshr_b32 s59, s58, 6
    s_and_b32 s60, s58, 63
    s_mul_i32 s59, s59, 196608
    s_mul_i32 s60, s60, 1536
    s_add_u32 s59, s59, s60
    s_add_u32 s62, s59, s56
    s_cmp_eq_u32 s63, 31
    s_cselect_b32 s62, 0x80000000, s62
    buffer_load_dwordx4 v[196:199], v12, s[36:39], s62 offen offset:0 nt
    buffer_load_dwordx4 v[200:203], v12, s[36:39], s62 offen offset:128 nt
    buffer_load_dwordx4 v[204:207], v12, s[36:39], s62 offen offset:256 nt
    s_add_u32 s58, s58, 4
    s_add_u32 s26, s26, 1
L_skipA_50:
    s_cmp_eq_u32 s14, 3
    s_cbranch_scc0 L_skipB_51
    s_sub_u32 s61, s26, s27
    s_cmp_eq_u32 s61, 9
    s_cbranch_scc0 L_skipB_51
    s_and_b32 s57, s57, 511
    s_lshr_b32 s59, s57, 6
    s_and_b32 s60, s57, 63
    s_mul_i32 s59, s59, 196608
    s_mul_i32 s60, s60, 1536
    s_add_u32 s59, s59, s60
    s_add_u32 s62, s59, s56
    s_cmp_eq_u32 s63, 31
    s_cselect_b32 s62, 0x80000000, s62
    buffer_load_dwordx4 v[208:211], v12, s[32:35], s62 offen offset:0 nt
    buffer_load_dwordx4 v[212:215], v12, s[32:35], s62 offen offset:128 nt
    buffer_load_dwordx4 v[216:219], v12, s[32:35], s62 offen offset:256 nt
    s_add_u32 s57, s57, 4
    s_add_u32 s26, s26, 1
L_skipB_51:
    s_add_u32 s60, s27, 8
    s_lshr_b32 s60, s60, 1
    v_mov_b32 v13, s60
    ds_write_b32 v14, v13 offset:2000
    s_add_u32 s27, s27, 8
    s_add_u32 s63, s63, 1
    s_cmp_lg_u32 s63, 32
    s_cbranch_scc1 L_loop_12
wb_s0_p0:
    s_cbranch_execz wb_s0_p1
    v_mov_b32 v59, v52
    s_nop 1
    v_max_f32_dpp v59, v59, v59 row_ror:8 row_mask:0xf bank_mask:0xf
    s_nop 0
    v_readlane_b32 s66, v59, 0
    v_readlane_b32 s67, v59, 16
    v_readlane_b32 s68, v59, 32
    v_readlane_b32 s69, v59, 48
    v_mov_b32 v60, s66
    v_max_f32 v60, s67, v60
    v_max_f32 v60, s68, v60
    v_max_f32 v59, s69, v60
    v_sub_f32 v60, v52, v59
    v_mul_f32 v60, s64, v60
    v_exp_f32 v60, v60
    v_lshrrev_b32 v8, 4, v1
    s_lshl_b32 s59, s3, 2
    v_add_u32 v8, s59, v8
    v_mul_u32_u24 v8, 784, v8
    v_lshlrev_b32 v9, 5, v4
    v_add_u32 v8, v8, v9
    v_mul_f32 v53, v53, v60
    v_mul_f32 v28, v28, v60
    v_mul_f32 v29, v29, v60
    v_mul_f32 v30, v30, v60
wb_s0_p1:
    s_cbranch_execz wb_s0_p2
    v_mul_f32 v31, v31, v60
    v_mul_f32 v32, v32, v60
    v_mul_f32 v33, v33, v60
    v_mul_f32 v34, v34, v60
    v_mul_f32 v35, v35, v60
    v_mul_f32 v36, v36, v60
    v_mul_f32 v37, v37, v60
    v_mul_f32 v38, v38, v60
    v_mul_f32 v39, v39, v60
    v_mul_f32 v40, v40, v60
    v_mul_f32 v41, v41, v60
    v_mul_f32 v42, v42, v60
    v_mul_f32 v43, v43, v60
    v_mul_f32 v44, v44, v60
    v_mul_f32 v45, v45, v60
    v_mul_f32 v46, v46, v60
    v_mul_f32 v47, v47, v60
    v_mul_f32 v48, v48, v60
    v_mul_f32 v49, v49, v60
    v_mul_f32 v50, v50, v60
    v_mul_f32 v51, v51, v60
    v_add_f32_dpp v53, v53, v53 row_ror:8 row_mask:0xf bank_mask:0xf
    v_add_f32_dpp v28, v28, v28 row_ror:8 row_mask:0xf bank_mask:0xf
    v_add_f32_dpp v29, v29, v29 row_ror:8 row_mask:0xf bank_mask:0xf
    v_add_f32_dpp v30, v30, v30 row_ror:8 row_mask:0xf bank_mask:0xf
    v_add_f32_dpp v31, v31, v31 row_ror:8 row_mask:0xf bank_mask:0xf
wb_s0_p2:
    s_cbranch_execz wb_s0_p3
    v_add_f32_dpp v32, v32, v32 row_ror:8 row_mask:0xf bank_mask:0xf
    v_add_f32_dpp v33, v33, v33 row_ror:8 row_mask:0xf bank_mask:0xf
    v_add_f32_dpp v34, v34, v34 row_ror:8 row_mask:0xf bank_mask:0xf
    v_add_f32_dpp v35, v35, v35 row_ror:8 row_mask:0xf bank_mask:0xf
    v_add_f32_dpp v36, v36, v36 row_ror:8 row_mask:0xf bank_mask:0xf
    v_add_f32_dpp v37, v37, v37 row_ror:8 row_mask:0xf bank_mask:0xf
    v_add_f32_dpp v38, v38, v38 row_ror:8 row_mask:0xf bank_mask:0xf
    v_add_f32_dpp v39, v39, v39 row_ror:8 row_mask:0xf bank_mask:0xf
    v_add_f32_dpp v40, v40, v40 row_ror:8 row_mask:0xf bank_mask:0xf
    v_add_f32_dpp v41, v41, v41 row_ror:8 row_mask:0xf bank_mask:0xf
    v_add_f32_dpp v42, v42, v42 row_ror:8 row_mask:0xf bank_mask:0xf
    v_add_f32_dpp v43, v43, v43 row_ror:8 row_mask:0xf bank_mask:0xf
    v_add_f32_dpp v44, v44, v44 row_ror:8 row_mask:0xf bank_mask:0xf
    v_add_f32_dpp v45, v45, v45 row_ror:8 row_mask:0xf bank_mask:0xf
    v_add_f32_dpp v46, v46, v46 row_ror:8 row_mask:0xf bank_mask:0xf
wb_s0_p3:
    s_cbranch_execz wb_s0_p4
    v_add_f32_dpp v47, v47, v47 row_ror:8 row_mask:0xf bank_mask:0xf
    v_add_f32_dpp v48, v48, v48 row_ror:8 row_mask:0xf bank_mask:0xf
    v_add_f32_dpp v49, v49, v49 row_ror:8 row_mask:0xf bank_mask:0xf
    v_add_f32_dpp v50, v50, v50 row_ror:8 row_mask:0xf bank_mask:0xf
    v_add_f32_dpp v51, v51, v51 row_ror:8 row_mask:0xf bank_mask:0xf
    v_readlane_b32 s66, v53, 0
    v_readlane_b32 s67, v53, 16
    v_readlane_b32 s68, v53, 32
    v_readlane_b32 s69, v53, 48
    v_mov_b32 v60, s66
    v_add_f32 v60, s67, v60
    v_add_f32 v60, s68, v60
    v_add_f32 v53, s69, v60
    s_mov_b32 exec_lo, 0x00ff00ff
    s_mov_b32 exec_hi, 0x00ff00ff
    ds_write_b128 v8, v[28:31] offset:2048
    ds_write_b128 v8, v[32:35] offset:2064
wb_s0_p4:
    s_cbranch_execz wb_s0_p5
    ds_write_b128 v8, v[36:39] offset:2304
    ds_write_b128 v8, v[40:43] offset:2320
    ds_write_b128 v8, v[44:47] offset:2560
    ds_write_b128 v8, v[48:51] offset:2576
    s_mov_b64 exec, 1
    s_lshl_b32 s59, s3, 3
    v_mov_b32 v8, s59
    v_mov_b32 v60, v59
    v_mov_b32 v61, v53
    ds_write_b64 v8, v[60:61] offset:1664
    s_mov_b64 exec, -1
    s_waitcnt vmcnt(0) lgkmcnt(0)
    s_barrier
    ds_read_b128 v[224:227], v5 offset:2048
    ds_read_b64 v[60:61], v6 offset:1664
    ds_read_b128 v[64:67], v7 offset:0
    ds_read_b128 v[68:71], v7 offset:1024
    ds_read_b128 v[72:75], v7 offset:2048
    ds_read_b128 v[76:79], v7 offset:3072
wb_s0_p5:
    s_cbranch_execz wb_s0_p6
    ds_read_b128 v[80:83], v7 offset:4096
    ds_read_b128 v[84:87], v7 offset:5120
    ds_read_b128 v[88:91], v7 offset:6144
    ds_read_b128 v[92:95], v7 offset:7168
    ds_read_b128 v[96:99], v7 offset:8192
    ds_read_b128 v[100:103], v7 offset:9216
    ds_read_b128 v[104:107], v7 offset:10240
    ds_read_b128 v[108:111], v7 offset:11264
    ds_read_b128 v[112:115], v7 offset:12288
    ds_read_b128 v[116:119], v7 offset:13312
    ds_read_b128 v[120:123], v7 offset:14336
    ds_read_b128 v[124:127], v7 offset:15360
    ds_read_b128 v[128:131], v7 offset:16384
    ds_read_b128 v[132:135], v7 offset:17408
    ds_read_b128 v[136:139], v7 offset:18432
wb_s0_p6:
    s_cbranch_execz wb_s0_p7
    ds_read_b128 v[140:143], v7 offset:19456
    s_waitcnt lgkmcnt(15)
    v_mov_b32 v59, v60
    s_nop 1
    v_max_f32_dpp v59, v59, v59 row_ror:8 row_mask:0xf bank_mask:0xf
    s_nop 1
    v_max_f32_dpp v59, v59, v59 row_ror:4 row_mask:0xf bank_mask:0xf
    v_sub_f32 v60, v60, v59
    v_mul_f32 v60, s64, v60
    v_exp_f32 v60, v60
    s_nop 0
    v_mul_f32 v61, v61, v60
    s_nop 1
    v_add_f32_dpp v61, v61, v61 row_ror:8 row_mask:0xf bank_mask:0xf
    s_nop 1
    v_add_f32_dpp v61, v61, v61 row_ror:4 row_mask:0xf bank_mask:0xf
    v_rcp_f32 v61, v61
    s_nop 0
    v_mul_f32 v60, v60, v61
    v_mul_f32 v224, v224, v60
    v_mul_f32 v225, v225, v60
    v_mul_f32 v226, v226, v60
    v_mul_f32 v227, v227, v60
    v_add_f32_dpp v224, v224, v224 row_ror:8 row_mask:0xf bank_mask:0xf
wb_s0_p7:
    s_cbranch_execz wb_s0_p8
    v_add_f32_dpp v225, v225, v225 row_ror:8 row_mask:0xf bank_mask:0xf
    v_add_f32_dpp v226, v226, v226 row_ror:8 row_mask:0xf bank_mask:0xf
    v_add_f32_dpp v227, v227, v227 row_ror:8 row_mask:0xf bank_mask:0xf
    v_add_f32_dpp v224, v224, v224 row_ror:4 row_mask:0xf bank_mask:0xf
    v_add_f32_dpp v225, v225, v225 row_ror:4 row_mask:0xf bank_mask:0xf
    v_add_f32_dpp v226, v226, v226 row_ror:4 row_mask:0xf bank_mask:0xf
    v_add_f32_dpp v227, v227, v227 row_ror:4 row_mask:0xf bank_mask:0xf
    v_add_f32_dpp v224, v224, v224 row_ror:2 row_mask:0xf bank_mask:0xf
    v_add_f32_dpp v225, v225, v225 row_ror:2 row_mask:0xf bank_mask:0xf
    v_add_f32_dpp v226, v226, v226 row_ror:2 row_mask:0xf bank_mask:0xf
    v_add_f32_dpp v227, v227, v227 row_ror:2 row_mask:0xf bank_mask:0xf
    v_add_f32_dpp v224, v224, v224 row_ror:1 row_mask:0xf bank_mask:0xf
    v_add_f32_dpp v225, v225, v225 row_ror:1 row_mask:0xf bank_mask:0xf
    v_add_f32_dpp v226, v226, v226 row_ror:1 row_mask:0xf bank_mask:0xf
    v_add_f32_dpp v227, v227, v227 row_ror:1 row_mask:0xf bank_mask:0xf
wb_s0_p8:
    s_cbranch_execz wb_s0_p9
    v_cvt_pk_bf16_f32 v232, v224, v225
    v_cvt_pk_bf16_f32 v233, v226, v227
    s_waitcnt lgkmcnt(0)
    v_dot2_f32_bf16 v16, v64, v232, 0
    v_dot2_f32_bf16 v17, v84, v232, 0
    v_dot2_f32_bf16 v18, v65, v232, 0
    v_dot2_f32_bf16 v19, v85, v232, 0
    v_dot2_f32_bf16 v20, v66, v232, 0
    v_dot2_f32_bf16 v21, v86, v232, 0
    v_dot2_f32_bf16 v22, v67, v232, 0
    v_dot2_f32_bf16 v23, v87, v232, 0
    v_dot2_f32_bf16 v24, v68, v232, 0
    v_dot2_f32_bf16 v25, v88, v232, 0
    v_dot2_f32_bf16 v26, v69, v232, 0
    v_dot2_f32_bf16 v27, v89, v232, 0
    v_dot2_f32_bf16 v28, v70, v232, 0
wb_s0_p9:
    s_cbranch_execz wb_ret
    v_dot2_f32_bf16 v29, v90, v232, 0
    v_dot2_f32_bf16 v30, v71, v232, 0
    v_dot2_f32_bf16 v31, v91, v232, 0
    v_dot2_f32_bf16 v32, v72, v232, 0
    v_dot2_f32_bf16 v33, v92, v232, 0
    v_dot2_f32_bf16 v34, v73, v232, 0
    v_dot2_f32_bf16 v35, v93, v232, 0
    v_dot2_f32_bf16 v36, v74, v232, 0
    v_dot2_f32_bf16 v37, v94, v232, 0
    v_dot2_f32_bf16 v38, v75, v232, 0
    v_dot2_f32_bf16 v39, v95, v232, 0
    v_dot2_f32_bf16 v40, v76, v232, 0
    v_dot2_f32_bf16 v41, v96, v232, 0
    v_dot2_f32_bf16 v42, v77, v232, 0
    v_dot2_f32_bf16 v43, v97, v232, 0
wb_s1_p0:
    s_cbranch_execz wb_s1_p1
    v_dot2_f32_bf16 v44, v78, v232, 0
    v_dot2_f32_bf16 v45, v98, v232, 0
    v_dot2_f32_bf16 v46, v79, v232, 0
    v_dot2_f32_bf16 v47, v99, v232, 0
    v_dot2_f32_bf16 v48, v80, v232, 0
    v_dot2_f32_bf16 v49, v100, v232, 0
    v_dot2_f32_bf16 v50, v81, v232, 0
    v_dot2_f32_bf16 v51, v101, v232, 0
    v_dot2_f32_bf16 v52, v82, v232, 0
    v_dot2_f32_bf16 v53, v102, v232, 0
    v_dot2_f32_bf16 v54, v83, v232, 0
    v_dot2_f32_bf16 v55, v103, v232, 0
    v_dot2c_f32_bf16 v16, v104, v233
    v_dot2c_f32_bf16 v17, v124, v233
    v_dot2c_f32_bf16 v18, v105, v233
    v_dot2c_f32_bf16 v19, v125, v233
    v_dot2c_f32_bf16 v20, v106, v233
    v_dot2c_f32_bf16 v21, v126, v233
    v_dot2c_f32_bf16 v22, v107, v233
wb_s1_p1:
    s_cbranch_execz wb_s1_p2
    v_dot2c_f32_bf16 v23, v127, v233
    v_dot2c_f32_bf16 v24, v108, v233
    v_dot2c_f32_bf16 v25, v128, v233
    v_dot2c_f32_bf16 v26, v109, v233
    v_dot2c_f32_bf16 v27, v129, v233
    v_dot2c_f32_bf16 v28, v110, v233
    v_dot2c_f32_bf16 v29, v130, v233
    v_dot2c_f32_bf16 v30, v111, v233
    v_dot2c_f32_bf16 v31, v131, v233
    v_dot2c_f32_bf16 v32, v112, v233
    v_dot2c_f32_bf16 v33, v132, v233
    v_dot2c_f32_bf16 v34, v113, v233
    v_dot2c_f32_bf16 v35, v133, v233
    v_dot2c_f32_bf16 v36, v114, v233
    v_dot2c_f32_bf16 v37, v134, v233
    v_dot2c_f32_bf16 v38, v115, v233
    v_dot2c_f32_bf16 v39, v135, v233
    v_dot2c_f32_bf16 v40, v116, v233
    v_dot2c_f32_bf16 v41, v136, v233
    v_dot2c_f32_bf16 v42, v117, v233
    v_dot2c_f32_bf16 v43, v137, v233
    v_dot2c_f32_bf16 v44, v118, v233
    v_dot2c_f32_bf16 v45, v138, v233
    v_dot2c_f32_bf16 v46, v119, v233
    v_dot2c_f32_bf16 v47, v139, v233
    v_dot2c_f32_bf16 v48, v120, v233
    v_dot2c_f32_bf16 v49, v140, v233
    v_dot2c_f32_bf16 v50, v121, v233
    v_dot2c_f32_bf16 v51, v141, v233
    v_dot2c_f32_bf16 v52, v122, v233
    v_dot2c_f32_bf16 v53, v142, v233
wb_s1_p2:
    s_cbranch_execz wb_s1_p3
    v_dot2c_f32_bf16 v54, v123, v233
    v_dot2c_f32_bf16 v55, v143, v233
    s_branch L_epi
L_aux_epi:
    v_and_b32 v9, 15, v1
    v_mul_u32_u24 v5, 784, v9
    v_lshrrev_b32 v11, 4, v1
    v_mul_u32_u24 v11, 32, v11
    v_add_u32 v5, v5, v11
    s_lshl_b32 s59, s98, 7
    s_add_u32 s59, s59, 256
    v_add_u32 v5, s59, v5
    v_lshrrev_b32 v6, 2, v9
    v_lshlrev_b32 v6, 3, v6
    s_barrier
    ds_read_b128 v[224:227], v5 offset:2048
    ds_read_b128 v[228:231], v5 offset:2064
    ds_read_b64 v[60:61], v6 offset:1664
    s_waitcnt lgkmcnt(0)
    v_mov_b32 v59, v60
    s_nop 1
    v_max_f32_dpp v59, v59, v59 row_ror:8 row_mask:0xf bank_mask:0xf
    s_nop 1
    v_max_f32_dpp v59, v59, v59 row_ror:4 row_mask:0xf bank_mask:0xf
    v_sub_f32 v60, v60, v59
wb_s1_p3:
    s_cbranch_execz wb_s1_p4
    v_mul_f32 v60, s64, v60
    v_exp_f32 v60, v60
    s_nop 0
    v_mul_f32 v61, v61, v60
    s_nop 1
    v_add_f32_dpp v61, v61, v61 row_ror:8 row_mask:0xf bank_mask:0xf
    s_nop 1
    v_add_f32_dpp v61, v61, v61 row_ror:4 row_mask:0xf bank_mask:0xf
    v_rcp_f32 v61, v61
    s_nop 0
    v_mul_f32 v60, v60, v61
    v_mul_f32 v224, v224, v60
    v_mul_f32 v225, v225, v60
    v_mul_f32 v226, v226, v60
    v_mul_f32 v227, v227, v60
    v_mul_f32 v228, v228, v60
    v_mul_f32 v229, v229, v60
    v_mul_f32 v230, v230, v60
    v_mul_f32 v231, v231, v60
    v_add_f32_dpp v224, v224, v224 row_ror:8 row_mask:0xf bank_mask:0xf
    v_add_f32_dpp v225, v225, v225 row_ror:8 row_mask:0xf bank_mask:0xf
    v_add_f32_dpp v226, v226, v226 row_ror:8 row_mask:0xf bank_mask:0xf
    v_add_f32_dpp v227, v227, v227 row_ror:8 row_mask:0xf bank_mask:0xf
    v_add_f32_dpp v228, v228, v228 row_ror:8 row_mask:0xf bank_mask:0xf
wb_s1_p4:
    s_cbranch_execz wb_s1_p5
    v_add_f32_dpp v229, v229, v229 row_ror:8 row_mask:0xf bank_mask:0xf
    v_add_f32_dpp v230, v230, v230 row_ror:8 row_mask:0xf bank_mask:0xf
    v_add_f32_dpp v231, v231, v231 row_ror:8 row_mask:0xf bank_mask:0xf
    v_add_f32_dpp v224, v224, v224 row_ror:4 row_mask:0xf bank_mask:0xf
    v_add_f32_dpp v225, v225, v225 row_ror:4 row_mask:0xf bank_mask:0xf
    v_add_f32_dpp v226, v226, v226 row_ror:4 row_mask:0xf bank_mask:0xf
    v_add_f32_dpp v227, v227, v227 row_ror:4 row_mask:0xf bank_mask:0xf
    v_add_f32_dpp v228, v228, v228 row_ror:4 row_mask:0xf bank_mask:0xf
    v_add_f32_dpp v229, v229, v229 row_ror:4 row_mask:0xf bank_mask:0xf
    v_add_f32_dpp v230, v230, v230 row_ror:4 row_mask:0xf bank_mask:0xf
    v_add_f32_dpp v231, v231, v231 row_ror:4 row_mask:0xf bank_mask:0xf
    v_add_f32_dpp v224, v224, v224 row_ror:2 row_mask:0xf bank_mask:0xf
    v_add_f32_dpp v225, v225, v225 row_ror:2 row_mask:0xf bank_mask:0xf
    v_add_f32_dpp v226, v226, v226 row_ror:2 row_mask:0xf bank_mask:0xf
    v_add_f32_dpp v227, v227, v227 row_ror:2 row_mask:0xf bank_mask:0xf
wb_s1_p5:
    s_cbranch_execz wb_s1_p6
    v_add_f32_dpp v228, v228, v228 row_ror:2 row_mask:0xf bank_mask:0xf
    v_add_f32_dpp v229, v229, v229 row_ror:2 row_mask:0xf bank_mask:0xf
    v_add_f32_dpp v230, v230, v230 row_ror:2 row_mask:0xf bank_mask:0xf
    v_add_f32_dpp v231, v231, v231 row_ror:2 row_mask:0xf bank_mask:0xf
    v_add_f32_dpp v224, v224, v224 row_ror:1 row_mask:0xf bank_mask:0xf
    v_add_f32_dpp v225, v225, v225 row_ror:1 row_mask:0xf bank_mask:0xf
    v_add_f32_dpp v226, v226, v226 row_ror:1 row_mask:0xf bank_mask:0xf
    v_add_f32_dpp v227, v227, v227 row_ror:1 row_mask:0xf bank_mask:0xf
    v_add_f32_dpp v228, v228, v228 row_ror:1 row_mask:0xf bank_mask:0xf
    v_add_f32_dpp v229, v229, v229 row_ror:1 row_mask:0xf bank_mask:0xf
    v_add_f32_dpp v230, v230, v230 row_ror:1 row_mask:0xf bank_mask:0xf
    v_add_f32_dpp v231, v231, v231 row_ror:1 row_mask:0xf bank_mask:0xf
    v_cvt_pk_bf16_f32 v232, v224, v225
    v_cvt_pk_bf16_f32 v233, v226, v227
    v_cvt_pk_bf16_f32 v234, v228, v229
wb_s1_p6:
    s_cbranch_execz wb_s1_p7
    v_cvt_pk_bf16_f32 v235, v230, v231
    v_dot2_f32_bf16 v16, v64, v232, 0
    v_dot2_f32_bf16 v17, v84, v232, 0
    v_dot2_f32_bf16 v18, v65, v232, 0
    v_dot2_f32_bf16 v19, v85, v232, 0
    v_dot2_f32_bf16 v20, v66, v232, 0
    v_dot2_f32_bf16 v21, v86, v232, 0
    v_dot2_f32_bf16 v22, v67, v232, 0
    v_dot2_f32_bf16 v23, v87, v232, 0
    v_dot2_f32_bf16 v24, v68, v232, 0
    v_dot2_f32_bf16 v25, v88, v232, 0
    v_dot2_f32_bf16 v26, v69, v232, 0
    v_dot2_f32_bf16 v27, v89, v232, 0
    v_dot2_f32_bf16 v28, v70, v232, 0
    v_dot2_f32_bf16 v29, v90, v232, 0
wb_s1_p7:
    s_cbranch_execz wb_s1_p8
    v_dot2_f32_bf16 v30, v71, v232, 0
    v_dot2_f32_bf16 v31, v91, v232, 0
    v_dot2_f32_bf16 v32, v72, v232, 0
    v_dot2_f32_bf16 v33, v92, v232, 0
    v_dot2_f32_bf16 v34, v73, v232, 0
    v_dot2_f32_bf16 v35, v93, v232, 0
    v_dot2_f32_bf16 v36, v74, v232, 0
    v_dot2_f32_bf16 v37, v94, v232, 0
    v_dot2_f32_bf16 v38, v75, v232, 0
    v_dot2_f32_bf16 v39, v95, v232, 0
    v_dot2_f32_bf16 v40, v76, v232, 0
    v_dot2_f32_bf16 v41, v96, v232, 0
    v_dot2_f32_bf16 v42, v77, v232, 0
    v_dot2_f32_bf16 v43, v97, v232, 0
    v_dot2_f32_bf16 v44, v78, v232, 0
wb_s1_p8:
    s_cbranch_execz wb_s1_p9
    v_dot2_f32_bf16 v45, v98, v232, 0
    v_dot2_f32_bf16 v46, v79, v232, 0
    v_dot2_f32_bf16 v47, v99, v232, 0
    v_dot2_f32_bf16 v48, v80, v232, 0
    v_dot2_f32_bf16 v49, v100, v232, 0
    v_dot2_f32_bf16 v50, v81, v232, 0
    v_dot2_f32_bf16 v51, v101, v232, 0
    v_dot2_f32_bf16 v52, v82, v232, 0
    v_dot2_f32_bf16 v53, v102, v232, 0
    v_dot2_f32_bf16 v54, v83, v232, 0
    v_dot2_f32_bf16 v55, v103, v232, 0
    v_dot2c_f32_bf16 v16, v104, v233
    v_dot2c_f32_bf16 v17, v124, v233
    v_dot2c_f32_bf16 v18, v105, v233
    v_dot2c_f32_bf16 v19, v125, v233
    v_dot2c_f32_bf16 v20, v106, v233
    v_dot2c_f32_bf16 v21, v126, v233
    v_dot2c_f32_bf16 v22, v107, v233
    v_dot2c_f32_bf16 v23, v127, v233
    v_dot2c_f32_bf16 v24, v108, v233
wb_s1_p9:
    s_cbranch_execz wb_ret
    v_dot2c_f32_bf16 v25, v128, v233
    v_dot2c_f32_bf16 v26, v109, v233
    v_dot2c_f32_bf16 v27, v129, v233
    v_dot2c_f32_bf16 v28, v110, v233
    v_dot2c_f32_bf16 v29, v130, v233
    v_dot2c_f32_bf16 v30, v111, v233
    v_dot2c_f32_bf16 v31, v131, v233
    v_dot2c_f32_bf16 v32, v112, v233
    v_dot2c_f32_bf16 v33, v132, v233
    v_dot2c_f32_bf16 v34, v113, v233
    v_dot2c_f32_bf16 v35, v133, v233
    v_dot2c_f32_bf16 v36, v114, v233
    v_dot2c_f32_bf16 v37, v134, v233
    v_dot2c_f32_bf16 v38, v115, v233
    v_dot2c_f32_bf16 v39, v135, v233
    v_dot2c_f32_bf16 v40, v116, v233
    v_dot2c_f32_bf16 v41, v136, v233
    v_dot2c_f32_bf16 v42, v117, v233
    v_dot2c_f32_bf16 v43, v137, v233
    v_dot2c_f32_bf16 v44, v118, v233
    v_dot2c_f32_bf16 v45, v138, v233
    v_dot2c_f32_bf16 v46, v119, v233
    v_dot2c_f32_bf16 v47, v139, v233
    v_dot2c_f32_bf16 v48, v120, v233
    v_dot2c_f32_bf16 v49, v140, v233
    v_dot2c_f32_bf16 v50, v121, v233
    v_dot2c_f32_bf16 v51, v141, v233
    v_dot2c_f32_bf16 v52, v122, v233
    v_dot2c_f32_bf16 v53, v142, v233
    v_dot2c_f32_bf16 v54, v123, v233
    v_dot2c_f32_bf16 v55, v143, v233
wb_s2_p0:
    s_cbranch_execz wb_s2_p1
    v_dot2c_f32_bf16 v16, v144, v234
    v_dot2c_f32_bf16 v17, v164, v234
    v_dot2c_f32_bf16 v18, v145, v234
    v_dot2c_f32_bf16 v19, v165, v234
    v_dot2c_f32_bf16 v20, v146, v234
    v_dot2c_f32_bf16 v21, v166, v234
    v_dot2c_f32_bf16 v22, v147, v234
    v_dot2c_f32_bf16 v23, v167, v234
    v_dot2c_f32_bf16 v24, v148, v234
    v_dot2c_f32_bf16 v25, v168, v234
    v_dot2c_f32_bf16 v26, v149, v234
    v_dot2c_f32_bf16 v27, v169, v234
    v_dot2c_f32_bf16 v28, v150, v234
    v_dot2c_f32_bf16 v29, v170, v234
    v_dot2c_f32_bf16 v30, v151, v234
    v_dot2c_f32_bf16 v31, v171, v234
    v_dot2c_f32_bf16 v32, v152, v234
    v_dot2c_f32_bf16 v33, v172, v234
    v_dot2c_f32_bf16 v34, v153, v234
    v_dot2c_f32_bf16 v35, v173, v234
    v_dot2c_f32_bf16 v36, v154, v234
    v_dot2c_f32_bf16 v37, v174, v234
    v_dot2c_f32_bf16 v38, v155, v234
    v_dot2c_f32_bf16 v39, v175, v234
    v_dot2c_f32_bf16 v40, v156, v234
    v_dot2c_f32_bf16 v41, v176, v234
    v_dot2c_f32_bf16 v42, v157, v234
    v_dot2c_f32_bf16 v43, v177, v234
    v_dot2c_f32_bf16 v44, v158, v234
    v_dot2c_f32_bf16 v45, v178, v234
    v_dot2c_f32_bf16 v46, v159, v234
wb_s2_p1:
    s_cbranch_execz wb_s2_p2
    v_dot2c_f32_bf16 v47, v179, v234
    v_dot2c_f32_bf16 v48, v160, v234
    v_dot2c_f32_bf16 v49, v180, v234
    v_dot2c_f32_bf16 v50, v161, v234
    v_dot2c_f32_bf16 v51, v181, v234
    v_dot2c_f32_bf16 v52, v162, v234
    v_dot2c_f32_bf16 v53, v182, v234
    v_dot2c_f32_bf16 v54, v163, v234
    v_dot2c_f32_bf16 v55, v183, v234
    v_dot2c_f32_bf16 v16, v184, v235
    v_dot2c_f32_bf16 v17, v204, v235
    v_dot2c_f32_bf16 v18, v185, v235
    v_dot2c_f32_bf16 v19, v205, v235
    v_dot2c_f32_bf16 v20, v186, v235
    v_dot2c_f32_bf16 v21, v206, v235
    v_dot2c_f32_bf16 v22, v187, v235
    v_dot2c_f32_bf16 v23, v207, v235
    v_dot2c_f32_bf16 v24, v188, v235
    v_dot2c_f32_bf16 v25, v208, v235
    v_dot2c_f32_bf16 v26, v189, v235
    v_dot2c_f32_bf16 v27, v209, v235
    v_dot2c_f32_bf16 v28, v190, v235
    v_dot2c_f32_bf16 v29, v210, v235
    v_dot2c_f32_bf16 v30, v191, v235
    v_dot2c_f32_bf16 v31, v211, v235
    v_dot2c_f32_bf16 v32, v192, v235
    v_dot2c_f32_bf16 v33, v212, v235
    v_dot2c_f32_bf16 v34, v193, v235
    v_dot2c_f32_bf16 v35, v213, v235
    v_dot2c_f32_bf16 v36, v194, v235
    v_dot2c_f32_bf16 v37, v214, v235
wb_s2_p2:
    s_cbranch_execz wb_s2_p3
    v_dot2c_f32_bf16 v38, v195, v235
    v_dot2c_f32_bf16 v39, v215, v235
    v_dot2c_f32_bf16 v40, v196, v235
    v_dot2c_f32_bf16 v41, v216, v235
    v_dot2c_f32_bf16 v42, v197, v235
    v_dot2c_f32_bf16 v43, v217, v235
    v_dot2c_f32_bf16 v44, v198, v235
    v_dot2c_f32_bf16 v45, v218, v235
    v_dot2c_f32_bf16 v46, v199, v235
    v_dot2c_f32_bf16 v47, v219, v235
    v_dot2c_f32_bf16 v48, v200, v235
    v_dot2c_f32_bf16 v49, v220, v235
    v_dot2c_f32_bf16 v50, v201, v235
    v_dot2c_f32_bf16 v51, v221, v235
    v_dot2c_f32_bf16 v52, v202, v235
    v_dot2c_f32_bf16 v53, v222, v235
    v_dot2c_f32_bf16 v54, v203, v235
    v_dot2c_f32_bf16 v55, v223, v235
L_epi:
    v_permlane32_swap_b32 v16, v17
    v_permlane32_swap_b32 v18, v19
    v_permlane32_swap_b32 v20, v21
    v_permlane32_swap_b32 v22, v23
    v_permlane32_swap_b32 v24, v25
    v_permlane32_swap_b32 v26, v27
    v_permlane32_swap_b32 v28, v29
    v_permlane32_swap_b32 v30, v31
    v_permlane32_swap_b32 v32, v33
    v_permlane32_swap_b32 v34, v35
    v_permlane32_swap_b32 v36, v37
    v_permlane32_swap_b32 v38, v39
    v_permlane32_swap_b32 v40, v41
wb_s2_p3:
    s_cbranch_execz wb_s2_p4
    v_permlane32_swap_b32 v42, v43
    v_permlane32_swap_b32 v44, v45
    v_permlane32_swap_b32 v46, v47
    v_permlane32_swap_b32 v48, v49
    v_permlane32_swap_b32 v50, v51
    v_permlane32_swap_b32 v52, v53
    v_permlane32_swap_b32 v54, v55
    v_add_f32 v16, v16, v17
    v_add_f32 v18, v18, v19
    v_add_f32 v20, v20, v21
    v_add_f32 v22, v22, v23
    v_add_f32 v24, v24, v25
    v_add_f32 v26, v26, v27
    v_add_f32 v28, v28, v29
    v_add_f32 v30, v30, v31
    v_add_f32 v32, v32, v33
    v_add_f32 v34, v34, v35
    v_add_f32 v36, v36, v37
    v_add_f32 v38, v38, v39
    v_add_f32 v40, v40, v41
    v_add_f32 v42, v42, v43
    v_add_f32 v44, v44, v45
    v_add_f32 v46, v46, v47
    v_add_f32 v48, v48, v49
    v_add_f32 v50, v50, v51
    v_add_f32 v52, v52, v53
    v_add_f32 v54, v54, v55
    v_permlane16_swap_b32 v16, v18
    v_permlane16_swap_b32 v20, v22
    v_permlane16_swap_b32 v24, v26
    v_permlane16_swap_b32 v28, v30
wb_s2_p4:
    s_cbranch_execz wb_s2_p5
    v_permlane16_swap_b32 v32, v34
    v_permlane16_swap_b32 v36, v38
    v_permlane16_swap_b32 v40, v42
    v_permlane16_swap_b32 v44, v46
    v_permlane16_swap_b32 v48, v50
    v_permlane16_swap_b32 v52, v54
    v_add_f32 v16, v16, v18
    v_add_f32 v20, v20, v22
    v_add_f32 v24, v24, v26
    v_add_f32 v28, v28, v30
    v_add_f32 v32, v32, v34
    v_add_f32 v36, v36, v38
    v_add_f32 v40, v40, v42
    v_add_f32 v44, v44, v46
    v_add_f32 v48, v48, v50
    v_add_f32 v52, v52, v54
    v_lshrrev_b32 v11, 4, v1
    v_and_b32 v8, 1, v11
    v_lshlrev_b32 v8, 1, v8
    v_lshrrev_b32 v11, 1, v11
    v_or_b32 v8, v8, v11
    v_and_b32 v9, 15, v1
    v_mul_u32_u24 v8, 88, v8
    v_add_u32 v8, v8, v9
    v_lshlrev_b32 v8, 2, v8
    s_mul_i32 s59, s3, 2816
    v_add_u32 v8, s59, v8
    ds_write_b32 v8, v16 offset:14592
wb_s2_p5:
    s_cbranch_execz wb_s2_p6
    ds_write_b32 v8, v20 offset:16000
    ds_write_b32 v8, v24 offset:14656
    ds_write_b32 v8, v28 offset:16064
    ds_write_b32 v8, v32 offset:14720
    ds_write_b32 v8, v36 offset:16128
    ds_write_b32 v8, v40 offset:14784
    ds_write_b32 v8, v44 offset:16192
    ds_write_b32 v8, v48 offset:14848
    ds_write_b32 v8, v52 offset:16256
    s_waitcnt lgkmcnt(0)
    s_barrier
    s_cmp_ge_u32 s3, 5
    s_cbranch_scc1 L_fin
    v_and_b32 v8, 7, v1
    v_mul_u32_u24 v8, 88, v8
    v_lshrrev_b32 v9, 3, v1
    v_add_u32 v8, v8, v9
    v_lshlrev_b32 v8, 2, v8
    s_lshl_b32 s59, s3, 6
    v_add_u32 v8, s59, v8
wb_s2_p6:
    s_cbranch_execz wb_s2_p7
    ds_read_b32 v16, v8 offset:14592
    ds_read_b32 v17, v8 offset:17408
    ds_read_b32 v18, v8 offset:20224
    ds_read_b32 v19, v8 offset:23040
    ds_read_b32 v20, v8 offset:25856
    ds_read_b32 v21, v8 offset:28672
    ds_read_b32 v22, v8 offset:31488
    ds_read_b32 v23, v8 offset:34304
    ds_read_b32 v24, v8 offset:14624
    ds_read_b32 v25, v8 offset:17440
    ds_read_b32 v26, v8 offset:20256
    ds_read_b32 v27, v8 offset:23072
    ds_read_b32 v28, v8 offset:25888
    ds_read_b32 v29, v8 offset:28704
    ds_read_b32 v30, v8 offset:31520
wb_s2_p7:
    s_cbranch_execz wb_s2_p8
    ds_read_b32 v31, v8 offset:34336
    v_lshlrev_b32 v9, 2, v1
    s_mul_i32 s59, s30, 6144
    s_lshl_b32 s60, s3, 9
    s_add_u32 s60, s60, s59
    s_waitcnt lgkmcnt(0)
    v_add_f32 v16, v16, v20
    v_add_f32 v17, v17, v21
    v_add_f32 v18, v18, v22
    v_add_f32 v19, v19, v23
    v_add_f32 v24, v24, v28
    v_add_f32 v25, v25, v29
    v_add_f32 v26, v26, v30
    v_add_f32 v27, v27, v31
    v_add_f32 v16, v16, v18
    v_add_f32 v17, v17, v19
    v_add_f32 v24, v24, v26
    v_add_f32 v25, v25, v27
    v_add_f32 v16, v16, v17
    v_add_f32 v24, v24, v25
    buffer_atomic_add_f32 v16, v9, s[52:55], s60 offen offset:0
    buffer_atomic_add_f32 v24, v9, s[52:55], s60 offen offset:256
    s_waitcnt vmcnt(0)
    v_mov_b32 v10, 0
    v_mov_b32 v11, 1
    s_mov_b64 exec, 1
wb_s2_p8:
    s_cbranch_execz wb_s2_p9
    ds_add_rtn_u32 v11, v10, v11 offset:1988
    s_mov_b64 exec, -1
    s_waitcnt lgkmcnt(0)
    v_readfirstlane_b32 s60, v11
    s_nop 0
    s_cmp_lg_u32 s60, 4
    s_cbranch_scc1 L_fin
    s_mov_b32 s40, s4
    s_and_b32 s41, s5, 0xffff
    s_mov_b32 s42, 10240
    s_mov_b32 s43, 0x20000
    s_mov_b32 s44, s22
    s_and_b32 s45, s23, 0xffff
    s_mov_b32 s46, 1280
    s_mov_b32 s47, 0x20000
    s_mov_b32 s32, s24
    s_and_b32 s33, s25, 0xffff
    s_mov_b32 s34, 10240
    s_mov_b32 s35, 0x20000
    s_mul_i32 s61, s30, 1280
wb_s2_p9:
    s_cbranch_execz wb_ret
    s_add_u32 s60, s59, 5120
    v_mov_b32 v8, 1
    v_mov_b32 v11, 0
    s_mov_b64 exec, 1
    buffer_atomic_add v8, v11, s[52:55], s60 offen sc0
    s_mov_b64 exec, -1
    buffer_load_dword v36, v9, s[40:43], s61 offen offset:0
    buffer_load_dword v41, v9, s[44:47], 0 offen offset:0
    buffer_load_dword v37, v9, s[40:43], s61 offen offset:256
    buffer_load_dword v42, v9, s[44:47], 0 offen offset:256
    buffer_load_dword v38, v9, s[40:43], s61 offen offset:512
    buffer_load_dword v43, v9, s[44:47], 0 offen offset:512
    buffer_load_dword v39, v9, s[40:43], s61 offen offset:768
    buffer_load_dword v44, v9, s[44:47], 0 offen offset:768
    buffer_load_dword v40, v9, s[40:43], s61 offen offset:1024
    buffer_load_dword v45, v9, s[44:47], 0 offen offset:1024
    s_waitcnt vmcnt(10)
    v_readfirstlane_b32 s60, v8
    s_nop 0
wb_s3_p0:
    s_cbranch_execz wb_s3_p1
    s_cmp_lg_u32 s60, 31
    s_cbranch_scc1 L_fin
    v_lshlrev_b32 v10, 3, v1
    s_add_u32 s60, s59, 2560
    buffer_load_dwordx2 v[16:17], v10, s[52:55], s59 offen offset:0 sc1
    buffer_load_dwordx2 v[26:27], v10, s[52:55], s60 offen offset:0 sc1
    buffer_load_dwordx2 v[18:19], v10, s[52:55], s59 offen offset:512 sc1
    buffer_load_dwordx2 v[28:29], v10, s[52:55], s60 offen offset:512 sc1
    buffer_load_dwordx2 v[20:21], v10, s[52:55], s59 offen offset:1024 sc1
    buffer_load_dwordx2 v[30:31], v10, s[52:55], s60 offen offset:1024 sc1
    buffer_load_dwordx2 v[22:23], v10, s[52:55], s59 offen offset:1536 sc1
    buffer_load_dwordx2 v[32:33], v10, s[52:55], s60 offen offset:1536 sc1
    buffer_load_dwordx2 v[24:25], v10, s[52:55], s59 offen offset:2048 sc1
    buffer_load_dwordx2 v[34:35], v10, s[52:55], s60 offen offset:2048 sc1
    s_waitcnt vmcnt(0)
    v_lshlrev_b32 v57, 16, v36
    v_lshlrev_b32 v58, 16, v41
    v_cvt_pk_bf16_f32 v16, 0, v16
wb_s3_p1:
    s_cbranch_execz wb_s3_p2
    v_cvt_pk_bf16_f32 v26, 0, v26
    v_add_f32 v26, v26, v58
    v_cvt_pk_bf16_f32 v26, 0, v26
    v_mul_f32 v59, 0xbfb8aa3b, v26
    v_exp_f32 v59, v59
    s_nop 0
    v_add_f32 v59, 1.0, v59
    v_rcp_f32 v59, v59
    s_nop 0
    v_mul_f32 v26, v26, v59
    v_cvt_pk_bf16_f32 v26, 0, v26
    v_mul_f32 v16, v16, v26
    v_cvt_pk_bf16_f32 v16, 0, v16
    v_add_f32 v16, v57, v16
    v_and_b32 v57, 0xffff0000, v36
    v_and_b32 v58, 0xffff0000, v41
    v_cvt_pk_bf16_f32 v17, 0, v17
    v_cvt_pk_bf16_f32 v27, 0, v27
    v_add_f32 v27, v27, v58
    v_cvt_pk_bf16_f32 v27, 0, v27
wb_s3_p2:
    s_cbranch_execz wb_s3_p3
    v_mul_f32 v59, 0xbfb8aa3b, v27
    v_exp_f32 v59, v59
    s_nop 0
    v_add_f32 v59, 1.0, v59
    v_rcp_f32 v59, v59
    s_nop 0
    v_mul_f32 v27, v27, v59
    v_cvt_pk_bf16_f32 v27, 0, v27
    v_mul_f32 v17, v17, v27
    v_cvt_pk_bf16_f32 v17, 0, v17
    v_add_f32 v17, v57, v17
    v_cvt_pk_bf16_f32 v46, v16, v17
    v_lshlrev_b32 v57, 16, v37
    v_lshlrev_b32 v58, 16, v42
    v_cvt_pk_bf16_f32 v18, 0, v18
    v_cvt_pk_bf16_f32 v28, 0, v28
    v_add_f32 v28, v28, v58
    v_cvt_pk_bf16_f32 v28, 0, v28
    v_mul_f32 v59, 0xbfb8aa3b, v28
    v_exp_f32 v59, v59
    s_nop 0
    v_add_f32 v59, 1.0, v59
    v_rcp_f32 v59, v59
wb_s3_p3:
    s_cbranch_execz wb_s3_p4
    s_nop 0
    v_mul_f32 v28, v28, v59
    v_cvt_pk_bf16_f32 v28, 0, v28
    v_mul_f32 v18, v18, v28
    v_cvt_pk_bf16_f32 v18, 0, v18
    v_add_f32 v18, v57, v18
    v_and_b32 v57, 0xffff0000, v37
    v_and_b32 v58, 0xffff0000, v42
    v_cvt_pk_bf16_f32 v19, 0, v19
    v_cvt_pk_bf16_f32 v29, 0, v29
    v_add_f32 v29, v29, v58
    v_cvt_pk_bf16_f32 v29, 0, v29
    v_mul_f32 v59, 0xbfb8aa3b, v29
    v_exp_f32 v59, v59
    s_nop 0
    v_add_f32 v59, 1.0, v59
    v_rcp_f32 v59, v59
    s_nop 0
    v_mul_f32 v29, v29, v59
    v_cvt_pk_bf16_f32 v29, 0, v29
    v_mul_f32 v19, v19, v29
wb_s3_p4:
    s_cbranch_execz wb_s3_p5
    v_cvt_pk_bf16_f32 v19, 0, v19
    v_add_f32 v19, v57, v19
    v_cvt_pk_bf16_f32 v47, v18, v19
    v_lshlrev_b32 v57, 16, v38
    v_lshlrev_b32 v58, 16, v43
    v_cvt_pk_bf16_f32 v20, 0, v20
    v_cvt_pk_bf16_f32 v30, 0, v30
    v_add_f32 v30, v30, v58
    v_cvt_pk_bf16_f32 v30, 0, v30
    v_mul_f32 v59, 0xbfb8aa3b, v30
    v_exp_f32 v59, v59
    s_nop 0
    v_add_f32 v59, 1.0, v59
    v_rcp_f32 v59, v59
    s_nop 0
    v_mul_f32 v30, v30, v59
    v_cvt_pk_bf16_f32 v30, 0, v30
    v_mul_f32 v20, v20, v30
    v_cvt_pk_bf16_f32 v20, 0, v20
    v_add_f32 v20, v57, v20
    v_and_b32 v57, 0xffff0000, v38
wb_s3_p5:
    s_cbranch_execz wb_s3_p6
    v_and_b32 v58, 0xffff0000, v43
    v_cvt_pk_bf16_f32 v21, 0, v21
    v_cvt_pk_bf16_f32 v31, 0, v31
    v_add_f32 v31, v31, v58
    v_cvt_pk_bf16_f32 v31, 0, v31
    v_mul_f32 v59, 0xbfb8aa3b, v31
    v_exp_f32 v59, v59
    s_nop 0
    v_add_f32 v59, 1.0, v59
    v_rcp_f32 v59, v59
    s_nop 0
    v_mul_f32 v31, v31, v59
    v_cvt_pk_bf16_f32 v31, 0, v31
    v_mul_f32 v21, v21, v31
    v_cvt_pk_bf16_f32 v21, 0, v21
    v_add_f32 v21, v57, v21
    v_cvt_pk_bf16_f32 v48, v20, v21
    v_lshlrev_b32 v57, 16, v39
    v_lshlrev_b32 v58, 16, v44
    v_cvt_pk_bf16_f32 v22, 0, v22
    v_cvt_pk_bf16_f32 v32, 0, v32
wb_s3_p6:
    s_cbranch_execz wb_s3_p7
    v_add_f32 v32, v32, v58
    v_cvt_pk_bf16_f32 v32, 0, v32
    v_mul_f32 v59, 0xbfb8aa3b, v32
    v_exp_f32 v59, v59
    s_nop 0
    v_add_f32 v59, 1.0, v59
    v_rcp_f32 v59, v59
    s_nop 0
    v_mul_f32 v32, v32, v59
    v_cvt_pk_bf16_f32 v32, 0, v32
    v_mul_f32 v22, v22, v32
    v_cvt_pk_bf16_f32 v22, 0, v22
    v_add_f32 v22, v57, v22
    v_and_b32 v57, 0xffff0000, v39
    v_and_b32 v58, 0xffff0000, v44
    v_cvt_pk_bf16_f32 v23, 0, v23
    v_cvt_pk_bf16_f32 v33, 0, v33
    v_add_f32 v33, v33, v58
    v_cvt_pk_bf16_f32 v33, 0, v33
    v_mul_f32 v59, 0xbfb8aa3b, v33
    v_exp_f32 v59, v59
wb_s3_p7:
    s_cbranch_execz wb_s3_p8
    s_nop 0
    v_add_f32 v59, 1.0, v59
    v_rcp_f32 v59, v59
    s_nop 0
    v_mul_f32 v33, v33, v59
    v_cvt_pk_bf16_f32 v33, 0, v33
    v_mul_f32 v23, v23, v33
    v_cvt_pk_bf16_f32 v23, 0, v23
    v_add_f32 v23, v57, v23
    v_cvt_pk_bf16_f32 v49, v22, v23
    v_lshlrev_b32 v57, 16, v40
    v_lshlrev_b32 v58, 16, v45
    v_cvt_pk_bf16_f32 v24, 0, v24
    v_cvt_pk_bf16_f32 v34, 0, v34
    v_add_f32 v34, v34, v58
    v_cvt_pk_bf16_f32 v34, 0, v34
    v_mul_f32 v59, 0xbfb8aa3b, v34
    v_exp_f32 v59, v59
    s_nop 0
    v_add_f32 v59, 1.0, v59
    v_rcp_f32 v59, v59
    s_nop 0
    v_mul_f32 v34, v34, v59
wb_s3_p8:
    s_cbranch_execz wb_s3_p9
    v_cvt_pk_bf16_f32 v34, 0, v34
    v_mul_f32 v24, v24, v34
    v_cvt_pk_bf16_f32 v24, 0, v24
    v_add_f32 v24, v57, v24
    v_and_b32 v57, 0xffff0000, v40
    v_and_b32 v58, 0xffff0000, v45
    v_cvt_pk_bf16_f32 v25, 0, v25
    v_cvt_pk_bf16_f32 v35, 0, v35
    v_add_f32 v35, v35, v58
    v_cvt_pk_bf16_f32 v35, 0, v35
    v_mul_f32 v59, 0xbfb8aa3b, v35
    v_exp_f32 v59, v59
    s_nop 0
    v_add_f32 v59, 1.0, v59
    v_rcp_f32 v59, v59
    s_nop 0
    v_mul_f32 v35, v35, v59
    v_cvt_pk_bf16_f32 v35, 0, v35
    v_mul_f32 v25, v25, v35
    v_cvt_pk_bf16_f32 v25, 0, v25
    v_add_f32 v25, v57, v25
wb_s3_p9:
    s_cbranch_execz wb_ret
    v_cvt_pk_bf16_f32 v50, v24, v25
    buffer_store_dword v46, v9, s[32:35], s61 offen offset:0
    buffer_store_dword v47, v9, s[32:35], s61 offen offset:256
    buffer_store_dword v48, v9, s[32:35], s61 offen offset:512
    buffer_store_dword v49, v9, s[32:35], s61 offen offset:768
    buffer_store_dword v50, v9, s[32:35], s61 offen offset:1024
L_fin:
    s_endpgm
L_aux:
    s_waitcnt vmcnt(0)
    s_sub_u32 s98, s3, 4
    s_cmp_lg_u32 s3, 4
    s_cbranch_scc1 L_nozero_52
    s_lshl_b32 s59, s30, 2
    s_and_b32 s60, s2, 31
    s_cmp_lg_u32 s60, 0
    s_cbranch_scc1 L_nozero_52
    v_mov_b32 v16, 0
    v_mov_b32 v17, 0
    v_mov_b32 v18, 0
    v_mov_b32 v19, 0
    v_lshlrev_b32 v9, 4, v1
    s_mul_i32 s60, s30, 6144
    buffer_store_dwordx4 v[16:19], v9, s[52:55], s60 offen offset:0 sc1
    buffer_store_dwordx4 v[16:19], v9, s[52:55], s60 offen offset:1024 sc1
    buffer_store_dwordx4 v[16:19], v9, s[52:55], s60 offen offset:2048 sc1
    buffer_store_dwordx4 v[16:19], v9, s[52:55], s60 offen offset:3072 sc1
    s_add_u32 s60, s60, 4096
    buffer_store_dwordx4 v[16:19], v9, s[52:55], s60 offen offset:0 sc1
    buffer_store_dwordx4 v[16:19], v9, s[52:55], s60 offen offset:1024 sc1
    s_waitcnt vmcnt(0)
    s_add_u32 s59, s59, 32
    v_mov_b32 v8, 1
    v_mov_b32 v9, 0
    s_mov_b64 exec, 1
    buffer_store_dword v8, v9, s[48:51], s59 offen sc1
    s_mov_b64 exec, -1
    s_waitcnt vmcnt(0)
L_nozero_52:
    s_cmp_ge_u32 s101, 24
    s_cbranch_scc1 L_noffn_53
    s_lshl_b32 s99, s101, 6
    s_lshl_b32 s59, s98, 4
    s_add_u32 s99, s99, s59
    s_mov_b32 s40, s16
    s_and_b32 s41, s17, 0xffff
    s_mov_b32 s42, 1966080
    s_mov_b32 s43, 0x20000
    s_mov_b32 s44, s20
    s_and_b32 s45, s21, 0xffff
    s_mov_b32 s46, 1966080
    s_mov_b32 s47, 0x20000
    s_mov_b32 s32, s18
    s_and_b32 s33, s19, 0xffff
    s_mov_b32 s34, 3072
    s_mov_b32 s35, 0x20000
    v_lshrrev_b32 v8, 1, v1
    v_and_b32 v9, 1, v1
    v_mul_u32_u24 v10, 61440, v8
    v_lshlrev_b32 v11, 4, v9
    v_add_u32 v10, v10, v11
    s_lshl_b32 s60, s99, 1
    buffer_load_dwordx4 v[224:227], v11, s[32:35], s60 offen
    v_mul_u32_u24 v8, 40, v8
    ds_read_b64 v[228:229], v8 offset:0
    ds_read_b64 v[230:231], v8 offset:8
    ds_read_b64 v[232:233], v8 offset:16
    ds_read_b64 v[234:235], v8 offset:24
    ds_read_b64 v[236:237], v8 offset:32
    v_mov_b32 v28, 0
    v_mov_b32 v29, 0
    v_mov_b32 v30, 0
    v_mov_b32 v31, 0
    v_mov_b32 v32, 0
    v_mov_b32 v33, 0
    v_mov_b32 v34, 0
    v_mov_b32 v35, 0
    buffer_load_dwordx4 v[64:67], v10, s[40:43], s60 offen
    s_add_u32 s60, s60, 3072
    v_lshrrev_b32 v14, 4, v1
    v_mul_u32_u24 v14, 5120, v14
    v_and_b32 v15, 15, v1
    v_lshlrev_b32 v15, 4, v15
    v_add_u32 v14, v14, v15
    s_mul_i32 s96, s99, 1280
    s_waitcnt lgkmcnt(0)
    v_and_b32 v57, 0xffff, v228
    v_lshlrev_b32 v58, 16, v228
    s_waitcnt vmcnt(0)
    buffer_load_dwordx4 v[68:71], v10, s[40:43], s60 offen
    s_add_u32 s60, s60, 3072
    v_dot2c_f32_bf16 v28, v64, v57
    v_dot2c_f32_bf16 v29, v64, v58
    v_dot2c_f32_bf16 v30, v65, v57
    v_dot2c_f32_bf16 v31, v65, v58
    v_dot2c_f32_bf16 v32, v66, v57
    v_dot2c_f32_bf16 v33, v66, v58
    v_dot2c_f32_bf16 v34, v67, v57
    v_dot2c_f32_bf16 v35, v67, v58
    v_lshrrev_b32 v57, 16, v228
    v_and_b32 v58, 0xffff0000, v228
    s_waitcnt vmcnt(0)
    buffer_load_dwordx4 v[72:75], v10, s[40:43], s60 offen
    s_add_u32 s60, s60, 3072
    v_dot2c_f32_bf16 v28, v68, v57
    v_dot2c_f32_bf16 v29, v68, v58
    v_dot2c_f32_bf16 v30, v69, v57
    v_dot2c_f32_bf16 v31, v69, v58
    v_dot2c_f32_bf16 v32, v70, v57
    v_dot2c_f32_bf16 v33, v70, v58
    v_dot2c_f32_bf16 v34, v71, v57
    v_dot2c_f32_bf16 v35, v71, v58
    v_and_b32 v57, 0xffff, v229
    v_lshlrev_b32 v58, 16, v229
    s_waitcnt vmcnt(0)
    buffer_load_dwordx4 v[76:79], v10, s[40:43], s60 offen
    s_add_u32 s60, s60, 3072
    v_dot2c_f32_bf16 v28, v72, v57
    v_dot2c_f32_bf16 v29, v72, v58
    v_dot2c_f32_bf16 v30, v73, v57
    v_dot2c_f32_bf16 v31, v73, v58
    v_dot2c_f32_bf16 v32, v74, v57
    v_dot2c_f32_bf16 v33, v74, v58
    v_dot2c_f32_bf16 v34, v75, v57
    v_dot2c_f32_bf16 v35, v75, v58
    v_lshrrev_b32 v57, 16, v229
    v_and_b32 v58, 0xffff0000, v229
    s_waitcnt vmcnt(0)
    buffer_load_dwordx4 v[80:83], v10, s[40:43], s60 offen
    s_add_u32 s60, s60, 3072
    v_dot2c_f32_bf16 v28, v76, v57
    v_dot2c_f32_bf16 v29, v76, v58
    v_dot2c_f32_bf16 v30, v77, v57
    v_dot2c_f32_bf16 v31, v77, v58
    v_dot2c_f32_bf16 v32, v78, v57
    v_dot2c_f32_bf16 v33, v78, v58
    v_dot2c_f32_bf16 v34, v79, v57
    v_dot2c_f32_bf16 v35, v79, v58
    v_and_b32 v57, 0xffff, v230
    v_lshlrev_b32 v58, 16, v230
    s_waitcnt vmcnt(0)
    buffer_load_dwordx4 v[84:87], v10, s[40:43], s60 offen
    s_add_u32 s60, s60, 3072
    v_dot2c_f32_bf16 v28, v80, v57
    v_dot2c_f32_bf16 v29, v80, v58
    v_dot2c_f32_bf16 v30, v81, v57
    v_dot2c_f32_bf16 v31, v81, v58
    v_dot2c_f32_bf16 v32, v82, v57
    v_dot2c_f32_bf16 v33, v82, v58
    v_dot2c_f32_bf16 v34, v83, v57
    v_dot2c_f32_bf16 v35, v83, v58
    v_lshrrev_b32 v57, 16, v230
    v_and_b32 v58, 0xffff0000, v230
    s_waitcnt vmcnt(0)
    buffer_load_dwordx4 v[88:91], v10, s[40:43], s60 offen
    s_add_u32 s60, s60, 3072
    v_dot2c_f32_bf16 v28, v84, v57
    v_dot2c_f32_bf16 v29, v84, v58
    v_dot2c_f32_bf16 v30, v85, v57
    v_dot2c_f32_bf16 v31, v85, v58
    v_dot2c_f32_bf16 v32, v86, v57
    v_dot2c_f32_bf16 v33, v86, v58
    v_dot2c_f32_bf16 v34, v87, v57
    v_dot2c_f32_bf16 v35, v87, v58
    v_and_b32 v57, 0xffff, v231
    v_lshlrev_b32 v58, 16, v231
    s_waitcnt vmcnt(0)
    buffer_load_dwordx4 v[92:95], v10, s[40:43], s60 offen
    s_add_u32 s60, s60, 3072
    v_dot2c_f32_bf16 v28, v88, v57
    v_dot2c_f32_bf16 v29, v88, v58
    v_dot2c_f32_bf16 v30, v89, v57
    v_dot2c_f32_bf16 v31, v89, v58
    v_dot2c_f32_bf16 v32, v90, v57
    v_dot2c_f32_bf16 v33, v90, v58
    v_dot2c_f32_bf16 v34, v91, v57
    v_dot2c_f32_bf16 v35, v91, v58
    v_lshrrev_b32 v57, 16, v231
    v_and_b32 v58, 0xffff0000, v231
    s_waitcnt vmcnt(0)
    buffer_load_dwordx4 v[96:99], v10, s[40:43], s60 offen
    s_add_u32 s60, s60, 3072
    v_dot2c_f32_bf16 v28, v92, v57
    v_dot2c_f32_bf16 v29, v92, v58
    v_dot2c_f32_bf16 v30, v93, v57
    v_dot2c_f32_bf16 v31, v93, v58
    v_dot2c_f32_bf16 v32, v94, v57
    v_dot2c_f32_bf16 v33, v94, v58
    v_dot2c_f32_bf16 v34, v95, v57
    v_dot2c_f32_bf16 v35, v95, v58
    v_and_b32 v57, 0xffff, v232
    v_lshlrev_b32 v58, 16, v232
    s_waitcnt vmcnt(0)
    buffer_load_dwordx4 v[100:103], v10, s[40:43], s60 offen
    s_add_u32 s60, s60, 3072
    v_dot2c_f32_bf16 v28, v96, v57
    v_dot2c_f32_bf16 v29, v96, v58
    v_dot2c_f32_bf16 v30, v97, v57
    v_dot2c_f32_bf16 v31, v97, v58
    v_dot2c_f32_bf16 v32, v98, v57
    v_dot2c_f32_bf16 v33, v98, v58
    v_dot2c_f32_bf16 v34, v99, v57
    v_dot2c_f32_bf16 v35, v99, v58
    v_lshrrev_b32 v57, 16, v232
    v_and_b32 v58, 0xffff0000, v232
    s_waitcnt vmcnt(0)
    buffer_load_dwordx4 v[104:107], v10, s[40:43], s60 offen
    s_add_u32 s60, s60, 3072
    v_dot2c_f32_bf16 v28, v100, v57
    v_dot2c_f32_bf16 v29, v100, v58
    v_dot2c_f32_bf16 v30, v101, v57
    v_dot2c_f32_bf16 v31, v101, v58
    v_dot2c_f32_bf16 v32, v102, v57
    v_dot2c_f32_bf16 v33, v102, v58
    v_dot2c_f32_bf16 v34, v103, v57
    v_dot2c_f32_bf16 v35, v103, v58
    v_and_b32 v57, 0xffff, v233
    v_lshlrev_b32 v58, 16, v233
    s_waitcnt vmcnt(0)
    buffer_load_dwordx4 v[108:111], v10, s[40:43], s60 offen
    s_add_u32 s60, s60, 3072
    v_dot2c_f32_bf16 v28, v104, v57
    v_dot2c_f32_bf16 v29, v104, v58
    v_dot2c_f32_bf16 v30, v105, v57
    v_dot2c_f32_bf16 v31, v105, v58
    v_dot2c_f32_bf16 v32, v106, v57
    v_dot2c_f32_bf16 v33, v106, v58
    v_dot2c_f32_bf16 v34, v107, v57
    v_dot2c_f32_bf16 v35, v107, v58
    v_lshrrev_b32 v57, 16, v233
    v_and_b32 v58, 0xffff0000, v233
    s_waitcnt vmcnt(0)
    buffer_load_dwordx4 v[112:115], v10, s[40:43], s60 offen
    s_add_u32 s60, s60, 3072
    v_dot2c_f32_bf16 v28, v108, v57
    v_dot2c_f32_bf16 v29, v108, v58
    v_dot2c_f32_bf16 v30, v109, v57
    v_dot2c_f32_bf16 v31, v109, v58
    v_dot2c_f32_bf16 v32, v110, v57
    v_dot2c_f32_bf16 v33, v110, v58
    v_dot2c_f32_bf16 v34, v111, v57
    v_dot2c_f32_bf16 v35, v111, v58
    v_and_b32 v57, 0xffff, v234
    v_lshlrev_b32 v58, 16, v234
    s_waitcnt vmcnt(0)
    buffer_load_dwordx4 v[116:119], v10, s[40:43], s60 offen
    s_add_u32 s60, s60, 3072
    v_dot2c_f32_bf16 v28, v112, v57
    v_dot2c_f32_bf16 v29, v112, v58
    v_dot2c_f32_bf16 v30, v113, v57
    v_dot2c_f32_bf16 v31, v113, v58
    v_dot2c_f32_bf16 v32, v114, v57
    v_dot2c_f32_bf16 v33, v114, v58
    v_dot2c_f32_bf16 v34, v115, v57
    v_dot2c_f32_bf16 v35, v115, v58
    v_lshrrev_b32 v57, 16, v234
    v_and_b32 v58, 0xffff0000, v234
    s_waitcnt vmcnt(0)
    buffer_load_dwordx4 v[120:123], v10, s[40:43], s60 offen
    s_add_u32 s60, s60, 3072
    v_dot2c_f32_bf16 v28, v116, v57
    v_dot2c_f32_bf16 v29, v116, v58
    v_dot2c_f32_bf16 v30, v117, v57
    v_dot2c_f32_bf16 v31, v117, v58
    v_dot2c_f32_bf16 v32, v118, v57
    v_dot2c_f32_bf16 v33, v118, v58
    v_dot2c_f32_bf16 v34, v119, v57
    v_dot2c_f32_bf16 v35, v119, v58
    v_and_b32 v57, 0xffff, v235
    v_lshlrev_b32 v58, 16, v235
    s_waitcnt vmcnt(0)
    buffer_load_dwordx4 v[124:127], v10, s[40:43], s60 offen
    s_add_u32 s60, s60, 3072
    v_dot2c_f32_bf16 v28, v120, v57
    v_dot2c_f32_bf16 v29, v120, v58
    v_dot2c_f32_bf16 v30, v121, v57
    v_dot2c_f32_bf16 v31, v121, v58
    v_dot2c_f32_bf16 v32, v122, v57
    v_dot2c_f32_bf16 v33, v122, v58
    v_dot2c_f32_bf16 v34, v123, v57
    v_dot2c_f32_bf16 v35, v123, v58
    v_lshrrev_b32 v57, 16, v235
    v_and_b32 v58, 0xffff0000, v235
    s_waitcnt vmcnt(0)
    buffer_load_dwordx4 v[128:131], v10, s[40:43], s60 offen
    s_add_u32 s60, s60, 3072
    v_dot2c_f32_bf16 v28, v124, v57
    v_dot2c_f32_bf16 v29, v124, v58
    v_dot2c_f32_bf16 v30, v125, v57
    v_dot2c_f32_bf16 v31, v125, v58
    v_dot2c_f32_bf16 v32, v126, v57
    v_dot2c_f32_bf16 v33, v126, v58
    v_dot2c_f32_bf16 v34, v127, v57
    v_dot2c_f32_bf16 v35, v127, v58
    v_and_b32 v57, 0xffff, v236
    v_lshlrev_b32 v58, 16, v236
    s_waitcnt vmcnt(0)
    buffer_load_dwordx4 v[132:135], v10, s[40:43], s60 offen
    s_add_u32 s60, s60, 3072
    v_dot2c_f32_bf16 v28, v128, v57
    v_dot2c_f32_bf16 v29, v128, v58
    v_dot2c_f32_bf16 v30, v129, v57
    v_dot2c_f32_bf16 v31, v129, v58
    v_dot2c_f32_bf16 v32, v130, v57
    v_dot2c_f32_bf16 v33, v130, v58
    v_dot2c_f32_bf16 v34, v131, v57
    v_dot2c_f32_bf16 v35, v131, v58
    v_lshrrev_b32 v57, 16, v236
    v_and_b32 v58, 0xffff0000, v236
    s_waitcnt vmcnt(0)
    buffer_load_dwordx4 v[136:139], v10, s[40:43], s60 offen
    s_add_u32 s60, s60, 3072
    v_dot2c_f32_bf16 v28, v132, v57
    v_dot2c_f32_bf16 v29, v132, v58
    v_dot2c_f32_bf16 v30, v133, v57
    v_dot2c_f32_bf16 v31, v133, v58
    v_dot2c_f32_bf16 v32, v134, v57
    v_dot2c_f32_bf16 v33, v134, v58
    v_dot2c_f32_bf16 v34, v135, v57
    v_dot2c_f32_bf16 v35, v135, v58
    v_and_b32 v57, 0xffff, v237
    v_lshlrev_b32 v58, 16, v237
    s_waitcnt vmcnt(0)
    buffer_load_dwordx4 v[140:143], v10, s[40:43], s60 offen
    s_add_u32 s60, s60, 3072
    v_dot2c_f32_bf16 v28, v136, v57
    v_dot2c_f32_bf16 v29, v136, v58
    v_dot2c_f32_bf16 v30, v137, v57
    v_dot2c_f32_bf16 v31, v137, v58
    v_dot2c_f32_bf16 v32, v138, v57
    v_dot2c_f32_bf16 v33, v138, v58
    v_dot2c_f32_bf16 v34, v139, v57
    v_dot2c_f32_bf16 v35, v139, v58
    v_lshrrev_b32 v57, 16, v237
    v_and_b32 v58, 0xffff0000, v237
    s_waitcnt vmcnt(0)
    s_add_u32 s97, s96, 0
    buffer_load_dwordx4 v[144:147], v14, s[44:47], s97 offen offset:0
    v_dot2c_f32_bf16 v28, v140, v57
    v_dot2c_f32_bf16 v29, v140, v58
    v_dot2c_f32_bf16 v30, v141, v57
    v_dot2c_f32_bf16 v31, v141, v58
    v_dot2c_f32_bf16 v32, v142, v57
    v_dot2c_f32_bf16 v33, v142, v58
    v_dot2c_f32_bf16 v34, v143, v57
    v_dot2c_f32_bf16 v35, v143, v58
    s_waitcnt vmcnt(0)
    s_add_u32 s97, s96, 0
    buffer_load_dwordx4 v[148:151], v14, s[44:47], s97 offen offset:256
    s_waitcnt vmcnt(0)
    s_add_u32 s97, s96, 0
    buffer_load_dwordx4 v[152:155], v14, s[44:47], s97 offen offset:512
    s_waitcnt vmcnt(0)
    s_add_u32 s97, s96, 0
    buffer_load_dwordx4 v[156:159], v14, s[44:47], s97 offen offset:768
    s_waitcnt vmcnt(0)
    s_add_u32 s97, s96, 0
    buffer_load_dwordx4 v[160:163], v14, s[44:47], s97 offen offset:1024
    s_waitcnt vmcnt(0)
    s_add_u32 s97, s96, 1280
    buffer_load_dwordx4 v[164:167], v14, s[44:47], s97 offen offset:0
    s_waitcnt vmcnt(0)
    s_add_u32 s97, s96, 1280
    buffer_load_dwordx4 v[168:171], v14, s[44:47], s97 offen offset:256
    s_waitcnt vmcnt(0)
    s_add_u32 s97, s96, 1280
    buffer_load_dwordx4 v[172:175], v14, s[44:47], s97 offen offset:512
    s_waitcnt vmcnt(0)
    s_add_u32 s97, s96, 1280
    buffer_load_dwordx4 v[176:179], v14, s[44:47], s97 offen offset:768
    s_waitcnt vmcnt(0)
    s_add_u32 s97, s96, 1280
    buffer_load_dwordx4 v[180:183], v14, s[44:47], s97 offen offset:1024
    s_waitcnt vmcnt(0)
    s_add_u32 s97, s96, 2560
    buffer_load_dwordx4 v[184:187], v14, s[44:47], s97 offen offset:0
    s_waitcnt vmcnt(0)
    s_add_u32 s97, s96, 2560
    buffer_load_dwordx4 v[188:191], v14, s[44:47], s97 offen offset:256
    s_waitcnt vmcnt(0)
    s_add_u32 s97, s96, 2560
    buffer_load_dwordx4 v[192:195], v14, s[44:47], s97 offen offset:512
    s_waitcnt vmcnt(0)
    s_add_u32 s97, s96, 2560
    buffer_load_dwordx4 v[196:199], v14, s[44:47], s97 offen offset:768
    s_waitcnt vmcnt(0)
    s_add_u32 s97, s96, 2560
    buffer_load_dwordx4 v[200:203], v14, s[44:47], s97 offen offset:1024
    s_waitcnt vmcnt(0)
    s_add_u32 s97, s96, 3840
    buffer_load_dwordx4 v[204:207], v14, s[44:47], s97 offen offset:0
    s_waitcnt vmcnt(0)
    s_add_u32 s97, s96, 3840
    buffer_load_dwordx4 v[208:211], v14, s[44:47], s97 offen offset:256
    s_waitcnt vmcnt(0)
    s_add_u32 s97, s96, 3840
    buffer_load_dwordx4 v[212:215], v14, s[44:47], s97 offen offset:512
    s_waitcnt vmcnt(0)
    s_add_u32 s97, s96, 3840
    buffer_load_dwordx4 v[216:219], v14, s[44:47], s97 offen offset:768
    s_waitcnt vmcnt(0)
    s_add_u32 s97, s96, 3840
    buffer_load_dwordx4 v[220:223], v14, s[44:47], s97 offen offset:1024
    v_add_f32_dpp v28, v28, v28 row_ror:8 row_mask:0xf bank_mask:0xf
    v_add_f32_dpp v29, v29, v29 row_ror:8 row_mask:0xf bank_mask:0xf
    v_add_f32_dpp v30, v30, v30 row_ror:8 row_mask:0xf bank_mask:0xf
    v_add_f32_dpp v31, v31, v31 row_ror:8 row_mask:0xf bank_mask:0xf
    v_add_f32_dpp v32, v32, v32 row_ror:8 row_mask:0xf bank_mask:0xf
    v_add_f32_dpp v33, v33, v33 row_ror:8 row_mask:0xf bank_mask:0xf
    v_add_f32_dpp v34, v34, v34 row_ror:8 row_mask:0xf bank_mask:0xf
    v_add_f32_dpp v35, v35, v35 row_ror:8 row_mask:0xf bank_mask:0xf
    v_add_f32_dpp v28, v28, v28 row_ror:4 row_mask:0xf bank_mask:0xf
    v_add_f32_dpp v29, v29, v29 row_ror:4 row_mask:0xf bank_mask:0xf
    v_add_f32_dpp v30, v30, v30 row_ror:4 row_mask:0xf bank_mask:0xf
    v_add_f32_dpp v31, v31, v31 row_ror:4 row_mask:0xf bank_mask:0xf
    v_add_f32_dpp v32, v32, v32 row_ror:4 row_mask:0xf bank_mask:0xf
    v_add_f32_dpp v33, v33, v33 row_ror:4 row_mask:0xf bank_mask:0xf
    v_add_f32_dpp v34, v34, v34 row_ror:4 row_mask:0xf bank_mask:0xf
    v_add_f32_dpp v35, v35, v35 row_ror:4 row_mask:0xf bank_mask:0xf
    v_add_f32_dpp v28, v28, v28 row_ror:2 row_mask:0xf bank_mask:0xf
    v_add_f32_dpp v29, v29, v29 row_ror:2 row_mask:0xf bank_mask:0xf
    v_add_f32_dpp v30, v30, v30 row_ror:2 row_mask:0xf bank_mask:0xf
    v_add_f32_dpp v31, v31, v31 row_ror:2 row_mask:0xf bank_mask:0xf
    v_add_f32_dpp v32, v32, v32 row_ror:2 row_mask:0xf bank_mask:0xf
    v_add_f32_dpp v33, v33, v33 row_ror:2 row_mask:0xf bank_mask:0xf
    v_add_f32_dpp v34, v34, v34 row_ror:2 row_mask:0xf bank_mask:0xf
    v_add_f32_dpp v35, v35, v35 row_ror:2 row_mask:0xf bank_mask:0xf
    v_mov_b32 v36, v28
    v_mov_b32 v37, v29
    v_mov_b32 v38, v30
    v_mov_b32 v39, v31
    v_mov_b32 v40, v32
    v_mov_b32 v41, v33
    v_mov_b32 v42, v34
    v_mov_b32 v43, v35
    v_permlane16_swap_b32 v28, v36
    v_permlane16_swap_b32 v29, v37
    v_permlane16_swap_b32 v30, v38
    v_permlane16_swap_b32 v31, v39
    v_permlane16_swap_b32 v32, v40
    v_permlane16_swap_b32 v33, v41
    v_permlane16_swap_b32 v34, v42
    v_permlane16_swap_b32 v35, v43
    v_add_f32 v28, v28, v36
    v_add_f32 v29, v29, v37
    v_add_f32 v30, v30, v38
    v_add_f32 v31, v31, v39
    v_add_f32 v32, v32, v40
    v_add_f32 v33, v33, v41
    v_add_f32 v34, v34, v42
    v_add_f32 v35, v35, v43
    v_mov_b32 v36, v28
    v_mov_b32 v37, v29
    v_mov_b32 v38, v30
    v_mov_b32 v39, v31
    v_mov_b32 v40, v32
    v_mov_b32 v41, v33
    v_mov_b32 v42, v34
    v_mov_b32 v43, v35
    v_permlane32_swap_b32 v28, v36
    v_permlane32_swap_b32 v29, v37
    v_permlane32_swap_b32 v30, v38
    v_permlane32_swap_b32 v31, v39
    v_permlane32_swap_b32 v32, v40
    v_permlane32_swap_b32 v33, v41
    v_permlane32_swap_b32 v34, v42
    v_permlane32_swap_b32 v35, v43
    v_add_f32 v28, v28, v36
    v_add_f32 v29, v29, v37
    v_add_f32 v30, v30, v38
    v_add_f32 v31, v31, v39
    v_add_f32 v32, v32, v40
    v_add_f32 v33, v33, v41
    v_add_f32 v34, v34, v42
    v_add_f32 v35, v35, v43
    v_lshlrev_b32 v57, 16, v224
    v_cvt_pk_bf16_f32 v28, 0, v28
    v_add_f32 v28, v28, v57
    v_cvt_pk_bf16_f32 v28, 0, v28
    v_max_f32 v28, 0, v28
    v_mul_f32 v28, v28, v28
    v_cvt_pk_bf16_f32 v28, 0, v28
    v_and_b32 v57, 0xffff0000, v224
    v_cvt_pk_bf16_f32 v29, 0, v29
    v_add_f32 v29, v29, v57
    v_cvt_pk_bf16_f32 v29, 0, v29
    v_max_f32 v29, 0, v29
    v_mul_f32 v29, v29, v29
    v_cvt_pk_bf16_f32 v29, 0, v29
    v_lshlrev_b32 v57, 16, v225
    v_cvt_pk_bf16_f32 v30, 0, v30
    v_add_f32 v30, v30, v57
    v_cvt_pk_bf16_f32 v30, 0, v30
    v_max_f32 v30, 0, v30
    v_mul_f32 v30, v30, v30
    v_cvt_pk_bf16_f32 v30, 0, v30
    v_and_b32 v57, 0xffff0000, v225
    v_cvt_pk_bf16_f32 v31, 0, v31
    v_add_f32 v31, v31, v57
    v_cvt_pk_bf16_f32 v31, 0, v31
    v_max_f32 v31, 0, v31
    v_mul_f32 v31, v31, v31
    v_cvt_pk_bf16_f32 v31, 0, v31
    v_lshlrev_b32 v57, 16, v226
    v_cvt_pk_bf16_f32 v32, 0, v32
    v_add_f32 v32, v32, v57
    v_cvt_pk_bf16_f32 v32, 0, v32
    v_max_f32 v32, 0, v32
    v_mul_f32 v32, v32, v32
    v_cvt_pk_bf16_f32 v32, 0, v32
    v_and_b32 v57, 0xffff0000, v226
    v_cvt_pk_bf16_f32 v33, 0, v33
    v_add_f32 v33, v33, v57
    v_cvt_pk_bf16_f32 v33, 0, v33
    v_max_f32 v33, 0, v33
    v_mul_f32 v33, v33, v33
    v_cvt_pk_bf16_f32 v33, 0, v33
    v_lshlrev_b32 v57, 16, v227
    v_cvt_pk_bf16_f32 v34, 0, v34
    v_add_f32 v34, v34, v57
    v_cvt_pk_bf16_f32 v34, 0, v34
    v_max_f32 v34, 0, v34
    v_mul_f32 v34, v34, v34
    v_cvt_pk_bf16_f32 v34, 0, v34
    v_and_b32 v57, 0xffff0000, v227
    v_cvt_pk_bf16_f32 v35, 0, v35
    v_add_f32 v35, v35, v57
    v_cvt_pk_bf16_f32 v35, 0, v35
    v_max_f32 v35, 0, v35
    v_mul_f32 v35, v35, v35
    v_cvt_pk_bf16_f32 v35, 0, v35
    s_lshl_b32 s59, s98, 6
    v_lshlrev_b32 v8, 5, v9
    v_add_u32 v8, s59, v8
    s_mov_b64 exec, 3
    ds_write_b128 v8, v[28:31] offset:1696
    ds_write_b128 v8, v[32:35] offset:1712
    s_mov_b64 exec, -1
    v_lshrrev_b32 v8, 4, v1
    v_lshlrev_b32 v8, 4, v8
    v_add_u32 v8, s59, v8
    s_waitcnt lgkmcnt(0)
    ds_read_b128 v[228:231], v8 offset:1696
    v_mov_b32 v16, 0
    v_mov_b32 v17, 0
    v_mov_b32 v18, 0
    v_mov_b32 v19, 0
    v_mov_b32 v20, 0
    v_mov_b32 v21, 0
    v_mov_b32 v22, 0
    v_mov_b32 v23, 0
    v_mov_b32 v24, 0
    v_mov_b32 v25, 0
    v_mov_b32 v26, 0
    v_mov_b32 v27, 0
    v_mov_b32 v28, 0
    v_mov_b32 v29, 0
    v_mov_b32 v30, 0
    v_mov_b32 v31, 0
    v_mov_b32 v32, 0
    v_mov_b32 v33, 0
    v_mov_b32 v34, 0
    v_mov_b32 v35, 0
    v_mov_b32 v36, 0
    v_mov_b32 v37, 0
    v_mov_b32 v38, 0
    v_mov_b32 v39, 0
    v_mov_b32 v40, 0
    v_mov_b32 v41, 0
    v_mov_b32 v42, 0
    v_mov_b32 v43, 0
    v_mov_b32 v44, 0
    v_mov_b32 v45, 0
    v_mov_b32 v46, 0
    v_mov_b32 v47, 0
    v_mov_b32 v48, 0
    v_mov_b32 v49, 0
    v_mov_b32 v50, 0
    v_mov_b32 v51, 0
    v_mov_b32 v52, 0
    v_mov_b32 v53, 0
    v_mov_b32 v54, 0
    v_mov_b32 v55, 0
    s_waitcnt lgkmcnt(0)
    v_lshrrev_b32 v57, 16, v228
    v_dot2c_f32_bf16 v16, v144, v57
    v_dot2c_f32_bf16 v17, v144, v228
    v_dot2c_f32_bf16 v18, v145, v57
    v_dot2c_f32_bf16 v19, v145, v228
    v_dot2c_f32_bf16 v20, v146, v57
    v_dot2c_f32_bf16 v21, v146, v228
    v_dot2c_f32_bf16 v22, v147, v57
    v_dot2c_f32_bf16 v23, v147, v228
    v_dot2c_f32_bf16 v24, v148, v57
    v_dot2c_f32_bf16 v25, v148, v228
    v_dot2c_f32_bf16 v26, v149, v57
    v_dot2c_f32_bf16 v27, v149, v228
    v_dot2c_f32_bf16 v28, v150, v57
    v_dot2c_f32_bf16 v29, v150, v228
    v_dot2c_f32_bf16 v30, v151, v57
    v_dot2c_f32_bf16 v31, v151, v228
    v_dot2c_f32_bf16 v32, v152, v57
    v_dot2c_f32_bf16 v33, v152, v228
    v_dot2c_f32_bf16 v34, v153, v57
    v_dot2c_f32_bf16 v35, v153, v228
    v_dot2c_f32_bf16 v36, v154, v57
    v_dot2c_f32_bf16 v37, v154, v228
    v_dot2c_f32_bf16 v38, v155, v57
    v_dot2c_f32_bf16 v39, v155, v228
    v_dot2c_f32_bf16 v40, v156, v57
    v_dot2c_f32_bf16 v41, v156, v228
    v_dot2c_f32_bf16 v42, v157, v57
    v_dot2c_f32_bf16 v43, v157, v228
    v_dot2c_f32_bf16 v44, v158, v57
    v_dot2c_f32_bf16 v45, v158, v228
    v_dot2c_f32_bf16 v46, v159, v57
    v_dot2c_f32_bf16 v47, v159, v228
    v_dot2c_f32_bf16 v48, v160, v57
    v_dot2c_f32_bf16 v49, v160, v228
    v_dot2c_f32_bf16 v50, v161, v57
    v_dot2c_f32_bf16 v51, v161, v228
    v_dot2c_f32_bf16 v52, v162, v57
    v_dot2c_f32_bf16 v53, v162, v228
    v_dot2c_f32_bf16 v54, v163, v57
    v_dot2c_f32_bf16 v55, v163, v228
    v_lshrrev_b32 v57, 16, v229
    v_dot2c_f32_bf16 v16, v164, v57
    v_dot2c_f32_bf16 v17, v164, v229
    v_dot2c_f32_bf16 v18, v165, v57
    v_dot2c_f32_bf16 v19, v165, v229
    v_dot2c_f32_bf16 v20, v166, v57
    v_dot2c_f32_bf16 v21, v166, v229
    v_dot2c_f32_bf16 v22, v167, v57
    v_dot2c_f32_bf16 v23, v167, v229
    v_dot2c_f32_bf16 v24, v168, v57
    v_dot2c_f32_bf16 v25, v168, v229
    v_dot2c_f32_bf16 v26, v169, v57
    v_dot2c_f32_bf16 v27, v169, v229
    v_dot2c_f32_bf16 v28, v170, v57
    v_dot2c_f32_bf16 v29, v170, v229
    v_dot2c_f32_bf16 v30, v171, v57
    v_dot2c_f32_bf16 v31, v171, v229
    v_dot2c_f32_bf16 v32, v172, v57
    v_dot2c_f32_bf16 v33, v172, v229
    v_dot2c_f32_bf16 v34, v173, v57
    v_dot2c_f32_bf16 v35, v173, v229
    v_dot2c_f32_bf16 v36, v174, v57
    v_dot2c_f32_bf16 v37, v174, v229
    v_dot2c_f32_bf16 v38, v175, v57
    v_dot2c_f32_bf16 v39, v175, v229
    v_dot2c_f32_bf16 v40, v176, v57
    v_dot2c_f32_bf16 v41, v176, v229
    v_dot2c_f32_bf16 v42, v177, v57
    v_dot2c_f32_bf16 v43, v177, v229
    v_dot2c_f32_bf16 v44, v178, v57
    v_dot2c_f32_bf16 v45, v178, v229
    v_dot2c_f32_bf16 v46, v179, v57
    v_dot2c_f32_bf16 v47, v179, v229
    v_dot2c_f32_bf16 v48, v180, v57
    v_dot2c_f32_bf16 v49, v180, v229
    v_dot2c_f32_bf16 v50, v181, v57
    v_dot2c_f32_bf16 v51, v181, v229
    v_dot2c_f32_bf16 v52, v182, v57
    v_dot2c_f32_bf16 v53, v182, v229
    v_dot2c_f32_bf16 v54, v183, v57
    v_dot2c_f32_bf16 v55, v183, v229
    v_lshrrev_b32 v57, 16, v230
    v_dot2c_f32_bf16 v16, v184, v57
    v_dot2c_f32_bf16 v17, v184, v230
    v_dot2c_f32_bf16 v18, v185, v57
    v_dot2c_f32_bf16 v19, v185, v230
    v_dot2c_f32_bf16 v20, v186, v57
    v_dot2c_f32_bf16 v21, v186, v230
    v_dot2c_f32_bf16 v22, v187, v57
    v_dot2c_f32_bf16 v23, v187, v230
    v_dot2c_f32_bf16 v24, v188, v57
    v_dot2c_f32_bf16 v25, v188, v230
    v_dot2c_f32_bf16 v26, v189, v57
    v_dot2c_f32_bf16 v27, v189, v230
    v_dot2c_f32_bf16 v28, v190, v57
    v_dot2c_f32_bf16 v29, v190, v230
    v_dot2c_f32_bf16 v30, v191, v57
    v_dot2c_f32_bf16 v31, v191, v230
    v_dot2c_f32_bf16 v32, v192, v57
    v_dot2c_f32_bf16 v33, v192, v230
    v_dot2c_f32_bf16 v34, v193, v57
    v_dot2c_f32_bf16 v35, v193, v230
    v_dot2c_f32_bf16 v36, v194, v57
    v_dot2c_f32_bf16 v37, v194, v230
    v_dot2c_f32_bf16 v38, v195, v57
    v_dot2c_f32_bf16 v39, v195, v230
    v_dot2c_f32_bf16 v40, v196, v57
    v_dot2c_f32_bf16 v41, v196, v230
    v_dot2c_f32_bf16 v42, v197, v57
    v_dot2c_f32_bf16 v43, v197, v230
    v_dot2c_f32_bf16 v44, v198, v57
    v_dot2c_f32_bf16 v45, v198, v230
    v_dot2c_f32_bf16 v46, v199, v57
    v_dot2c_f32_bf16 v47, v199, v230
    v_dot2c_f32_bf16 v48, v200, v57
    v_dot2c_f32_bf16 v49, v200, v230
    v_dot2c_f32_bf16 v50, v201, v57
    v_dot2c_f32_bf16 v51, v201, v230
    v_dot2c_f32_bf16 v52, v202, v57
    v_dot2c_f32_bf16 v53, v202, v230
    v_dot2c_f32_bf16 v54, v203, v57
    v_dot2c_f32_bf16 v55, v203, v230
    v_lshrrev_b32 v57, 16, v231
    s_waitcnt vmcnt(0)
    v_dot2c_f32_bf16 v16, v204, v57
    v_dot2c_f32_bf16 v17, v204, v231
    v_dot2c_f32_bf16 v18, v205, v57
    v_dot2c_f32_bf16 v19, v205, v231
    v_dot2c_f32_bf16 v20, v206, v57
    v_dot2c_f32_bf16 v21, v206, v231
    v_dot2c_f32_bf16 v22, v207, v57
    v_dot2c_f32_bf16 v23, v207, v231
    v_dot2c_f32_bf16 v24, v208, v57
    v_dot2c_f32_bf16 v25, v208, v231
    v_dot2c_f32_bf16 v26, v209, v57
    v_dot2c_f32_bf16 v27, v209, v231
    v_dot2c_f32_bf16 v28, v210, v57
    v_dot2c_f32_bf16 v29, v210, v231
    v_dot2c_f32_bf16 v30, v211, v57
    v_dot2c_f32_bf16 v31, v211, v231
    v_dot2c_f32_bf16 v32, v212, v57
    v_dot2c_f32_bf16 v33, v212, v231
    v_dot2c_f32_bf16 v34, v213, v57
    v_dot2c_f32_bf16 v35, v213, v231
    v_dot2c_f32_bf16 v36, v214, v57
    v_dot2c_f32_bf16 v37, v214, v231
    v_dot2c_f32_bf16 v38, v215, v57
    v_dot2c_f32_bf16 v39, v215, v231
    v_dot2c_f32_bf16 v40, v216, v57
    v_dot2c_f32_bf16 v41, v216, v231
    v_dot2c_f32_bf16 v42, v217, v57
    v_dot2c_f32_bf16 v43, v217, v231
    v_dot2c_f32_bf16 v44, v218, v57
    v_dot2c_f32_bf16 v45, v218, v231
    v_dot2c_f32_bf16 v46, v219, v57
    v_dot2c_f32_bf16 v47, v219, v231
    v_dot2c_f32_bf16 v48, v220, v57
    v_dot2c_f32_bf16 v49, v220, v231
    v_dot2c_f32_bf16 v50, v221, v57
    v_dot2c_f32_bf16 v51, v221, v231
    v_dot2c_f32_bf16 v52, v222, v57
    v_dot2c_f32_bf16 v53, v222, v231
    v_dot2c_f32_bf16 v54, v223, v57
    v_dot2c_f32_bf16 v55, v223, v231
    v_permlane32_swap_b32 v16, v17
    v_permlane32_swap_b32 v18, v19
    v_permlane32_swap_b32 v20, v21
    v_permlane32_swap_b32 v22, v23
    v_permlane32_swap_b32 v24, v25
    v_permlane32_swap_b32 v26, v27
    v_permlane32_swap_b32 v28, v29
    v_permlane32_swap_b32 v30, v31
    v_permlane32_swap_b32 v32, v33
    v_permlane32_swap_b32 v34, v35
    v_permlane32_swap_b32 v36, v37
    v_permlane32_swap_b32 v38, v39
    v_permlane32_swap_b32 v40, v41
    v_permlane32_swap_b32 v42, v43
    v_permlane32_swap_b32 v44, v45
    v_permlane32_swap_b32 v46, v47
    v_permlane32_swap_b32 v48, v49
    v_permlane32_swap_b32 v50, v51
    v_permlane32_swap_b32 v52, v53
    v_permlane32_swap_b32 v54, v55
    v_add_f32 v16, v16, v17
    v_add_f32 v18, v18, v19
    v_add_f32 v20, v20, v21
    v_add_f32 v22, v22, v23
    v_add_f32 v24, v24, v25
    v_add_f32 v26, v26, v27
    v_add_f32 v28, v28, v29
    v_add_f32 v30, v30, v31
    v_add_f32 v32, v32, v33
    v_add_f32 v34, v34, v35
    v_add_f32 v36, v36, v37
    v_add_f32 v38, v38, v39
    v_add_f32 v40, v40, v41
    v_add_f32 v42, v42, v43
    v_add_f32 v44, v44, v45
    v_add_f32 v46, v46, v47
    v_add_f32 v48, v48, v49
    v_add_f32 v50, v50, v51
    v_add_f32 v52, v52, v53
    v_add_f32 v54, v54, v55
    v_permlane16_swap_b32 v16, v18
    v_permlane16_swap_b32 v20, v22
    v_permlane16_swap_b32 v24, v26
    v_permlane16_swap_b32 v28, v30
    v_permlane16_swap_b32 v32, v34
    v_permlane16_swap_b32 v36, v38
    v_permlane16_swap_b32 v40, v42
    v_permlane16_swap_b32 v44, v46
    v_permlane16_swap_b32 v48, v50
    v_permlane16_swap_b32 v52, v54
    v_add_f32 v16, v16, v18
    v_add_f32 v20, v20, v22
    v_add_f32 v24, v24, v26
    v_add_f32 v28, v28, v30
    v_add_f32 v32, v32, v34
    v_add_f32 v36, v36, v38
    v_add_f32 v40, v40, v42
    v_add_f32 v44, v44, v46
    v_add_f32 v48, v48, v50
    v_add_f32 v52, v52, v54
    v_lshrrev_b32 v11, 4, v1
    v_and_b32 v8, 1, v11
    v_lshlrev_b32 v8, 1, v8
    v_lshrrev_b32 v11, 1, v11
    v_or_b32 v8, v8, v11
    v_and_b32 v9, 15, v1
    v_mul_u32_u24 v8, 88, v8
    v_add_u32 v8, v8, v9
    v_lshlrev_b32 v8, 2, v8
    s_mul_i32 s59, s98, 2816
    v_add_u32 v8, s59, v8
    ds_write_b32 v8, v16 offset:14592
    ds_write_b32 v8, v20 offset:16000
    ds_write_b32 v8, v24 offset:14656
    ds_write_b32 v8, v28 offset:16064
    ds_write_b32 v8, v32 offset:14720
    ds_write_b32 v8, v36 offset:16128
    ds_write_b32 v8, v40 offset:14784
    ds_write_b32 v8, v44 offset:16192
    ds_write_b32 v8, v48 offset:14848
    ds_write_b32 v8, v52 offset:16256
    s_waitcnt lgkmcnt(0)
    v_mov_b32 v10, 0
    v_mov_b32 v11, 1
    s_mov_b64 exec, 1
    ds_add_rtn_u32 v11, v10, v11 offset:1984
    s_mov_b64 exec, -1
    s_waitcnt lgkmcnt(0)
    v_readfirstlane_b32 s60, v11
    s_nop 0
    s_cmp_lg_u32 s60, 3
    s_cbranch_scc1 L_ffndone_54
    v_and_b32 v8, 7, v1
    v_mul_u32_u24 v8, 88, v8
    v_lshrrev_b32 v9, 3, v1
    v_add_u32 v8, v8, v9
    v_lshlrev_b32 v8, 2, v8
    ds_read_b32 v16, v8 offset:14592
    ds_read_b32 v17, v8 offset:17408
    ds_read_b32 v18, v8 offset:20224
    ds_read_b32 v19, v8 offset:23040
    ds_read_b32 v20, v8 offset:14624
    ds_read_b32 v21, v8 offset:17440
    ds_read_b32 v22, v8 offset:20256
    ds_read_b32 v23, v8 offset:23072
    ds_read_b32 v24, v8 offset:14656
    ds_read_b32 v25, v8 offset:17472
    ds_read_b32 v26, v8 offset:20288
    ds_read_b32 v27, v8 offset:23104
    ds_read_b32 v28, v8 offset:14688
    ds_read_b32 v29, v8 offset:17504
    ds_read_b32 v30, v8 offset:20320
    ds_read_b32 v31, v8 offset:23136
    ds_read_b32 v32, v8 offset:14720
    ds_read_b32 v33, v8 offset:17536
    ds_read_b32 v34, v8 offset:20352
    ds_read_b32 v35, v8 offset:23168
    s_waitcnt lgkmcnt(0)
    ds_read_b32 v36, v8 offset:14752
    ds_read_b32 v37, v8 offset:17568
    ds_read_b32 v38, v8 offset:20384
    ds_read_b32 v39, v8 offset:23200
    ds_read_b32 v40, v8 offset:14784
    ds_read_b32 v41, v8 offset:17600
    ds_read_b32 v42, v8 offset:20416
    ds_read_b32 v43, v8 offset:23232
    ds_read_b32 v44, v8 offset:14816
    ds_read_b32 v45, v8 offset:17632
    ds_read_b32 v46, v8 offset:20448
    ds_read_b32 v47, v8 offset:23264
    ds_read_b32 v48, v8 offset:14848
    ds_read_b32 v49, v8 offset:17664
    ds_read_b32 v50, v8 offset:20480
    ds_read_b32 v51, v8 offset:23296
    ds_read_b32 v52, v8 offset:14880
    ds_read_b32 v53, v8 offset:17696
    ds_read_b32 v54, v8 offset:20512
    ds_read_b32 v55, v8 offset:23328
    s_waitcnt lgkmcnt(0)
    v_add_f32 v16, v16, v17
    v_add_f32 v18, v18, v19
    v_add_f32 v20, v20, v21
    v_add_f32 v22, v22, v23
    v_add_f32 v24, v24, v25
    v_add_f32 v26, v26, v27
    v_add_f32 v28, v28, v29
    v_add_f32 v30, v30, v31
    v_add_f32 v32, v32, v33
    v_add_f32 v34, v34, v35
    v_add_f32 v36, v36, v37
    v_add_f32 v38, v38, v39
    v_add_f32 v40, v40, v41
    v_add_f32 v42, v42, v43
    v_add_f32 v44, v44, v45
    v_add_f32 v46, v46, v47
    v_add_f32 v48, v48, v49
    v_add_f32 v50, v50, v51
    v_add_f32 v52, v52, v53
    v_add_f32 v54, v54, v55
    v_add_f32 v16, v16, v18
    v_add_f32 v20, v20, v22
    v_add_f32 v24, v24, v26
    v_add_f32 v28, v28, v30
    v_add_f32 v32, v32, v34
    v_add_f32 v36, v36, v38
    v_add_f32 v40, v40, v42
    v_add_f32 v44, v44, v46
    v_add_f32 v48, v48, v50
    v_add_f32 v52, v52, v54
    s_lshl_b32 s59, s30, 2
    s_add_u32 s59, s59, 32
    v_mov_b32 v57, 0
    s_mov_b32 s61, 0x200000
L_poll_55:
    buffer_load_dword v58, v57, s[48:51], s59 offen sc1
    s_waitcnt vmcnt(0)
    v_readfirstlane_b32 s60, v58
    s_nop 0
    s_cmp_lg_u32 s60, 0
    s_cbranch_scc1 L_pollok_56
    s_sub_u32 s61, s61, 1
    s_cmp_eq_u32 s61, 0
    s_cbranch_scc1 L_pollok_56
    s_sleep 32
    s_branch L_poll_55
L_pollok_56:
    v_lshlrev_b32 v9, 2, v1
    s_mul_i32 s59, s30, 6144
    s_add_u32 s59, s59, 2560
    buffer_atomic_add_f32 v16, v9, s[52:55], s59 offen offset:0
    buffer_atomic_add_f32 v20, v9, s[52:55], s59 offen offset:256
    buffer_atomic_add_f32 v24, v9, s[52:55], s59 offen offset:512
    buffer_atomic_add_f32 v28, v9, s[52:55], s59 offen offset:768
    buffer_atomic_add_f32 v32, v9, s[52:55], s59 offen offset:1024
    buffer_atomic_add_f32 v36, v9, s[52:55], s59 offen offset:1280
    buffer_atomic_add_f32 v40, v9, s[52:55], s59 offen offset:1536
    buffer_atomic_add_f32 v44, v9, s[52:55], s59 offen offset:1792
    buffer_atomic_add_f32 v48, v9, s[52:55], s59 offen offset:2048
    buffer_atomic_add_f32 v52, v9, s[52:55], s59 offen offset:2304
    s_branch L_ffndone_54
L_noffn_53:
    s_cmp_lg_u32 s3, 4
    s_cbranch_scc1 L_ffndone_54
    s_sleep 64
    s_lshl_b32 s59, s30, 2
    s_add_u32 s59, s59, 32
    v_mov_b32 v57, 0
    s_mov_b32 s61, 0x200000
L_poll_57:
    buffer_load_dword v58, v57, s[48:51], s59 offen sc1
    s_waitcnt vmcnt(0)
    v_readfirstlane_b32 s60, v58
    s_nop 0
    s_cmp_lg_u32 s60, 0
    s_cbranch_scc1 L_pollok_58
    s_sub_u32 s61, s61, 1
    s_cmp_eq_u32 s61, 0
    s_cbranch_scc1 L_pollok_58
    s_sleep 32
    s_branch L_poll_57
L_pollok_58:
L_ffndone_54:
    s_waitcnt vmcnt(0)
    s_cmp_lg_u32 s3, 4
    s_cbranch_scc1 L_xdone_59
    v_mov_b32 v8, 0
L_xspin_60:
    ds_read_b32 v9, v8 offset:2000
    s_waitcnt lgkmcnt(0)
    v_readfirstlane_b32 s59, v9
    s_nop 0
    s_cmp_ge_u32 s59, 37
    s_cbranch_scc1 L_xok_61
    s_sleep 8
    s_branch L_xspin_60
L_xok_61:
    ds_read_b32 v10, v8 offset:2024
    ds_read_b32 v11, v8 offset:2028
    s_waitcnt lgkmcnt(0)
    v_readfirstlane_b32 s60, v10
    v_readfirstlane_b32 s61, v11
    s_nop 0
    s_lshr_b32 s62, s61, 12
    s_and_b32 s62, s62, 0xffff
    s_lshl_b32 s63, s62, 16
    s_sub_u32 s66, s61, s0
    s_and_b32 s66, s66, 0xffff
    s_or_b32 s66, s66, s63
    s_sub_u32 s67, s61, s60
    s_and_b32 s67, s67, 0xffff
    s_or_b32 s67, s67, s63
    v_mov_b32 v10, s66
    v_mov_b32 v11, s67
    s_mul_i32 s59, s2, 37
    s_and_b32 s59, s59, 255
    s_lshl_b32 s59, s59, 3
    s_add_u32 s59, s59, 98304
    s_mov_b64 exec, 1
    buffer_store_dwordx2 v[10:11], v8, s[52:55], s59 offen sc1
    s_mov_b64 exec, -1
L_xspin_62:
    ds_read_b32 v9, v8 offset:2000
    s_waitcnt lgkmcnt(0)
    v_readfirstlane_b32 s59, v9
    s_nop 0
    s_cmp_ge_u32 s59, 42
    s_cbranch_scc1 L_xok_63
    s_sleep 8
    s_branch L_xspin_62
L_xok_63:
    v_lshlrev_b32 v9, 4, v1
    s_mov_b32 s59, 98304
    buffer_load_dwordx4 v[16:19], v9, s[52:55], s59 offen sc1
    buffer_load_dwordx4 v[20:23], v9, s[52:55], s59 offen offset:1024 sc1
    v_mov_b32 v24, 0
    v_mov_b32 v25, 0
    v_mov_b32 v26, 0
    s_add_u32 s62, s62, 1
    s_waitcnt vmcnt(0)
    v_lshrrev_b32 v27, 16, v16
    v_lshrrev_b32 v28, 16, v17
    v_cmp_eq_u32 vcc, v27, v28
    v_sub_u32 v27, s62, v27
    v_and_b32 v27, 0xffff, v27
    v_cmp_ge_u32 s[66:67], 2, v27
    s_nop 0
    s_and_b64 vcc, vcc, s[66:67]
    v_and_b32 v16, 0xffff, v16
    v_and_b32 v17, 0xffff, v17
    v_cndmask_b32 v16, 0, v16, vcc
    v_cndmask_b32 v17, 0, v17, vcc
    v_cndmask_b32 v27, 0, 1, vcc
    v_add_u32 v24, v24, v16
    v_add_u32 v25, v25, v17
    v_add_u32 v26, v26, v27
    v_lshrrev_b32 v27, 16, v18
    v_lshrrev_b32 v28, 16, v19
    v_cmp_eq_u32 vcc, v27, v28
    v_sub_u32 v27, s62, v27
    v_and_b32 v27, 0xffff, v27
    v_cmp_ge_u32 s[66:67], 2, v27
    s_nop 0
    s_and_b64 vcc, vcc, s[66:67]
    v_and_b32 v18, 0xffff, v18
    v_and_b32 v19, 0xffff, v19
    v_cndmask_b32 v18, 0, v18, vcc
    v_cndmask_b32 v19, 0, v19, vcc
    v_cndmask_b32 v27, 0, 1, vcc
    v_add_u32 v24, v24, v18
    v_add_u32 v25, v25, v19
    v_add_u32 v26, v26, v27
    v_lshrrev_b32 v27, 16, v20
    v_lshrrev_b32 v28, 16, v21
    v_cmp_eq_u32 vcc, v27, v28
    v_sub_u32 v27, s62, v27
    v_and_b32 v27, 0xffff, v27
    v_cmp_ge_u32 s[66:67], 2, v27
    s_nop 0
    s_and_b64 vcc, vcc, s[66:67]
    v_and_b32 v20, 0xffff, v20
    v_and_b32 v21, 0xffff, v21
    v_cndmask_b32 v20, 0, v20, vcc
    v_cndmask_b32 v21, 0, v21, vcc
    v_cndmask_b32 v27, 0, 1, vcc
    v_add_u32 v24, v24, v20
    v_add_u32 v25, v25, v21
    v_add_u32 v26, v26, v27
    v_lshrrev_b32 v27, 16, v22
    v_lshrrev_b32 v28, 16, v23
    v_cmp_eq_u32 vcc, v27, v28
    v_sub_u32 v27, s62, v27
    v_and_b32 v27, 0xffff, v27
    v_cmp_ge_u32 s[66:67], 2, v27
    s_nop 0
    s_and_b64 vcc, vcc, s[66:67]
    v_and_b32 v22, 0xffff, v22
    v_and_b32 v23, 0xffff, v23
    v_cndmask_b32 v22, 0, v22, vcc
    v_cndmask_b32 v23, 0, v23, vcc
    v_cndmask_b32 v27, 0, 1, vcc
    v_add_u32 v24, v24, v22
    v_add_u32 v25, v25, v23
    v_add_u32 v26, v26, v27
    v_cvt_f32_u32 v24, v24
    v_cvt_f32_u32 v25, v25
    v_cvt_f32_u32 v26, v26
    v_add_f32_dpp v24, v24, v24 row_ror:8 row_mask:0xf bank_mask:0xf
    v_add_f32_dpp v25, v25, v25 row_ror:8 row_mask:0xf bank_mask:0xf
    v_add_f32_dpp v26, v26, v26 row_ror:8 row_mask:0xf bank_mask:0xf
    v_add_f32_dpp v24, v24, v24 row_ror:4 row_mask:0xf bank_mask:0xf
    v_add_f32_dpp v25, v25, v25 row_ror:4 row_mask:0xf bank_mask:0xf
    v_add_f32_dpp v26, v26, v26 row_ror:4 row_mask:0xf bank_mask:0xf
    v_add_f32_dpp v24, v24, v24 row_ror:2 row_mask:0xf bank_mask:0xf
    v_add_f32_dpp v25, v25, v25 row_ror:2 row_mask:0xf bank_mask:0xf
    v_add_f32_dpp v26, v26, v26 row_ror:2 row_mask:0xf bank_mask:0xf
    v_add_f32_dpp v24, v24, v24 row_ror:1 row_mask:0xf bank_mask:0xf
    v_add_f32_dpp v25, v25, v25 row_ror:1 row_mask:0xf bank_mask:0xf
    v_add_f32_dpp v26, v26, v26 row_ror:1 row_mask:0xf bank_mask:0xf
    v_readlane_b32 s66, v24, 0
    v_readlane_b32 s67, v24, 16
    v_readlane_b32 s68, v24, 32
    v_readlane_b32 s69, v24, 48
    v_mov_b32 v27, s66
    v_add_f32 v27, s67, v27
    v_add_f32 v27, s68, v27
    v_add_f32 v24, s69, v27
    v_readlane_b32 s66, v25, 0
    v_readlane_b32 s67, v25, 16
    v_readlane_b32 s68, v25, 32
    v_readlane_b32 s69, v25, 48
    v_mov_b32 v27, s66
    v_add_f32 v27, s67, v27
    v_add_f32 v27, s68, v27
    v_add_f32 v25, s69, v27
    v_readlane_b32 s66, v26, 0
    v_readlane_b32 s67, v26, 16
    v_readlane_b32 s68, v26, 32
    v_readlane_b32 s69, v26, 48
    v_mov_b32 v27, s66
    v_add_f32 v27, s67, v27
    v_add_f32 v27, s68, v27
    v_add_f32 v26, s69, v27
    s_nop 0
    v_readfirstlane_b32 s59, v26
    s_nop 0
    s_cmp_eq_u32 s59, 0
    s_cbranch_scc1 L_xdone_59
    v_rcp_f32 v26, v26
    s_nop 0
    v_mul_f32 v24, v24, v26
    v_mul_f32 v25, v25, v26
    v_mul_f32 v25, 0x3f153620, v25
    v_cvt_u32_f32 v24, v24
    v_cvt_u32_f32 v25, v25
    v_add_u32 v24, s0, v24
    ds_write_b64 v8, v[24:25] offset:2016
    s_waitcnt lgkmcnt(0)
L_xdone_59:
    s_mov_b32 s44, s12
    s_and_b32 s45, s13, 0xffff
    s_mov_b32 s46, 7864320
    s_mov_b32 s47, 0x20000
    v_lshrrev_b32 v8, 4, v1
    v_mul_u32_u24 v8, 5120, v8
    v_and_b32 v9, 15, v1
    v_lshlrev_b32 v9, 4, v9
    v_add_u32 v14, v8, v9
    s_lshl_b32 s59, s98, 4
    s_mul_i32 s60, s31, 192
    s_add_u32 s60, s60, s59
    s_mul_i32 s60, s60, 1280
    buffer_load_dwordx4 v[64:67], v14, s[44:47], s60 offen offset:0
    buffer_load_dwordx4 v[68:71], v14, s[44:47], s60 offen offset:256
    s_waitcnt vmcnt(1)
    buffer_load_dwordx4 v[72:75], v14, s[44:47], s60 offen offset:512
    s_waitcnt vmcnt(1)
    buffer_load_dwordx4 v[76:79], v14, s[44:47], s60 offen offset:768
    s_waitcnt vmcnt(1)
    buffer_load_dwordx4 v[80:83], v14, s[44:47], s60 offen offset:1024
    s_add_u32 s60, s60, 1280
    s_waitcnt vmcnt(1)
    buffer_load_dwordx4 v[84:87], v14, s[44:47], s60 offen offset:0
    s_waitcnt vmcnt(1)
    buffer_load_dwordx4 v[88:91], v14, s[44:47], s60 offen offset:256
    s_waitcnt vmcnt(1)
    buffer_load_dwordx4 v[92:95], v14, s[44:47], s60 offen offset:512
    s_waitcnt vmcnt(1)
    buffer_load_dwordx4 v[96:99], v14, s[44:47], s60 offen offset:768
    s_waitcnt vmcnt(1)
    buffer_load_dwordx4 v[100:103], v14, s[44:47], s60 offen offset:1024
    s_add_u32 s60, s60, 1280
    s_waitcnt vmcnt(1)
    buffer_load_dwordx4 v[104:107], v14, s[44:47], s60 offen offset:0
    s_waitcnt vmcnt(1)
    buffer_load_dwordx4 v[108:111], v14, s[44:47], s60 offen offset:256
    s_waitcnt vmcnt(1)
    buffer_load_dwordx4 v[112:115], v14, s[44:47], s60 offen offset:512
    s_waitcnt vmcnt(1)
    buffer_load_dwordx4 v[116:119], v14, s[44:47], s60 offen offset:768
    s_waitcnt vmcnt(1)
    buffer_load_dwordx4 v[120:123], v14, s[44:47], s60 offen offset:1024
    s_add_u32 s60, s60, 1280
    s_waitcnt vmcnt(1)
    buffer_load_dwordx4 v[124:127], v14, s[44:47], s60 offen offset:0
    s_waitcnt vmcnt(1)
    buffer_load_dwordx4 v[128:131], v14, s[44:47], s60 offen offset:256
    s_waitcnt vmcnt(1)
    buffer_load_dwordx4 v[132:135], v14, s[44:47], s60 offen offset:512
    s_waitcnt vmcnt(1)
    buffer_load_dwordx4 v[136:139], v14, s[44:47], s60 offen offset:768
    s_waitcnt vmcnt(1)
    buffer_load_dwordx4 v[140:143], v14, s[44:47], s60 offen offset:1024
    s_waitcnt vmcnt(0)
    s_mov_b32 s66, 0x05040100
    s_mov_b32 s67, 0x07060302
    v_perm_b32 v59, v84, v64, s66
    v_perm_b32 v84, v84, v64, s67
    v_mov_b32 v64, v59
    v_perm_b32 v59, v85, v65, s66
    v_perm_b32 v85, v85, v65, s67
    v_mov_b32 v65, v59
    v_perm_b32 v59, v86, v66, s66
    v_perm_b32 v86, v86, v66, s67
    v_mov_b32 v66, v59
    v_perm_b32 v59, v87, v67, s66
    v_perm_b32 v87, v87, v67, s67
    v_mov_b32 v67, v59
    v_perm_b32 v59, v88, v68, s66
    v_perm_b32 v88, v88, v68, s67
    v_mov_b32 v68, v59
    v_perm_b32 v59, v89, v69, s66
    v_perm_b32 v89, v89, v69, s67
    v_mov_b32 v69, v59
    v_perm_b32 v59, v90, v70, s66
    v_perm_b32 v90, v90, v70, s67
    v_mov_b32 v70, v59
    v_perm_b32 v59, v91, v71, s66
    v_perm_b32 v91, v91, v71, s67
    v_mov_b32 v71, v59
    v_perm_b32 v59, v92, v72, s66
    v_perm_b32 v92, v92, v72, s67
    v_mov_b32 v72, v59
    v_perm_b32 v59, v93, v73, s66
    v_perm_b32 v93, v93, v73, s67
    v_mov_b32 v73, v59
    v_perm_b32 v59, v94, v74, s66
    v_perm_b32 v94, v94, v74, s67
    v_mov_b32 v74, v59
    v_perm_b32 v59, v95, v75, s66
    v_perm_b32 v95, v95, v75, s67
    v_mov_b32 v75, v59
    v_perm_b32 v59, v96, v76, s66
    v_perm_b32 v96, v96, v76, s67
    v_mov_b32 v76, v59
    v_perm_b32 v59, v97, v77, s66
    v_perm_b32 v97, v97, v77, s67
    v_mov_b32 v77, v59
    v_perm_b32 v59, v98, v78, s66
    v_perm_b32 v98, v98, v78, s67
    v_mov_b32 v78, v59
    v_perm_b32 v59, v99, v79, s66
    v_perm_b32 v99, v99, v79, s67
    v_mov_b32 v79, v59
    v_perm_b32 v59, v100, v80, s66
    v_perm_b32 v100, v100, v80, s67
    v_mov_b32 v80, v59
    v_perm_b32 v59, v101, v81, s66
    v_perm_b32 v101, v101, v81, s67
    v_mov_b32 v81, v59
    v_perm_b32 v59, v102, v82, s66
    v_perm_b32 v102, v102, v82, s67
    v_mov_b32 v82, v59
    v_perm_b32 v59, v103, v83, s66
    v_perm_b32 v103, v103, v83, s67
    v_mov_b32 v83, v59
    v_perm_b32 v59, v124, v104, s66
    v_perm_b32 v124, v124, v104, s67
    v_mov_b32 v104, v59
    v_perm_b32 v59, v125, v105, s66
    v_perm_b32 v125, v125, v105, s67
    v_mov_b32 v105, v59
    v_perm_b32 v59, v126, v106, s66
    v_perm_b32 v126, v126, v106, s67
    v_mov_b32 v106, v59
    v_perm_b32 v59, v127, v107, s66
    v_perm_b32 v127, v127, v107, s67
    v_mov_b32 v107, v59
    v_perm_b32 v59, v128, v108, s66
    v_perm_b32 v128, v128, v108, s67
    v_mov_b32 v108, v59
    v_perm_b32 v59, v129, v109, s66
    v_perm_b32 v129, v129, v109, s67
    v_mov_b32 v109, v59
    v_perm_b32 v59, v130, v110, s66
    v_perm_b32 v130, v130, v110, s67
    v_mov_b32 v110, v59
    v_perm_b32 v59, v131, v111, s66
    v_perm_b32 v131, v131, v111, s67
    v_mov_b32 v111, v59
    v_perm_b32 v59, v132, v112, s66
    v_perm_b32 v132, v132, v112, s67
    v_mov_b32 v112, v59
    v_perm_b32 v59, v133, v113, s66
    v_perm_b32 v133, v133, v113, s67
    v_mov_b32 v113, v59
    v_perm_b32 v59, v134, v114, s66
    v_perm_b32 v134, v134, v114, s67
    v_mov_b32 v114, v59
    v_perm_b32 v59, v135, v115, s66
    v_perm_b32 v135, v135, v115, s67
    v_mov_b32 v115, v59
    v_perm_b32 v59, v136, v116, s66
    v_perm_b32 v136, v136, v116, s67
    v_mov_b32 v116, v59
    v_perm_b32 v59, v137, v117, s66
    v_perm_b32 v137, v137, v117, s67
    v_mov_b32 v117, v59
    v_perm_b32 v59, v138, v118, s66
    v_perm_b32 v138, v138, v118, s67
    v_mov_b32 v118, v59
    v_perm_b32 v59, v139, v119, s66
    v_perm_b32 v139, v139, v119, s67
    v_mov_b32 v119, v59
    v_perm_b32 v59, v140, v120, s66
    v_perm_b32 v140, v140, v120, s67
    v_mov_b32 v120, v59
    v_perm_b32 v59, v141, v121, s66
    v_perm_b32 v141, v141, v121, s67
    v_mov_b32 v121, v59
    v_perm_b32 v59, v142, v122, s66
    v_perm_b32 v142, v142, v122, s67
    v_mov_b32 v122, v59
    v_perm_b32 v59, v143, v123, s66
    v_perm_b32 v143, v143, v123, s67
    v_mov_b32 v123, v59
    s_mul_i32 s59, s98, 20480
    v_lshlrev_b32 v8, 4, v1
    v_add_u32 v8, s59, v8
    v_add_u32 v8, 37120, v8
    ds_write_b128 v8, v[64:67] offset:0
    ds_write_b128 v8, v[68:71] offset:1024
    ds_write_b128 v8, v[72:75] offset:2048
    ds_write_b128 v8, v[76:79] offset:3072
    ds_write_b128 v8, v[80:83] offset:4096
    ds_write_b128 v8, v[84:87] offset:5120
    ds_write_b128 v8, v[88:91] offset:6144
    ds_write_b128 v8, v[92:95] offset:7168
    ds_write_b128 v8, v[96:99] offset:8192
    ds_write_b128 v8, v[100:103] offset:9216
    ds_write_b128 v8, v[104:107] offset:10240
    ds_write_b128 v8, v[108:111] offset:11264
    ds_write_b128 v8, v[112:115] offset:12288
    ds_write_b128 v8, v[116:119] offset:13312
    ds_write_b128 v8, v[120:123] offset:14336
    ds_write_b128 v8, v[124:127] offset:15360
    ds_write_b128 v8, v[128:131] offset:16384
    ds_write_b128 v8, v[132:135] offset:17408
    ds_write_b128 v8, v[136:139] offset:18432
    ds_write_b128 v8, v[140:143] offset:19456
    s_waitcnt lgkmcnt(0)
    s_mov_b32 s44, s12
    s_and_b32 s45, s13, 0xffff
    s_mov_b32 s46, 7864320
    s_mov_b32 s47, 0x20000
    v_lshrrev_b32 v8, 4, v1
    v_mul_u32_u24 v8, 10240, v8
    v_and_b32 v9, 15, v1
    v_lshlrev_b32 v9, 4, v9
    v_add_u32 v13, v8, v9
    s_lshl_b32 s97, s98, 5
    s_add_u32 s97, s97, 64
    s_mul_i32 s96, s31, 192
    s_add_u32 s96, s96, s97
    s_mul_i32 s96, s96, 1280
    s_mov_b32 s97, s96
    buffer_load_dwordx4 v[64:67], v13, s[44:47], s97 offen offset:0
    buffer_load_dwordx4 v[68:71], v13, s[44:47], s97 offen offset:256
    s_waitcnt vmcnt(1)
    buffer_load_dwordx4 v[72:75], v13, s[44:47], s97 offen offset:512
    s_waitcnt vmcnt(1)
    buffer_load_dwordx4 v[76:79], v13, s[44:47], s97 offen offset:768
    s_waitcnt vmcnt(1)
    buffer_load_dwordx4 v[80:83], v13, s[44:47], s97 offen offset:1024
    s_add_u32 s97, s97, 1280
    s_waitcnt vmcnt(1)
    buffer_load_dwordx4 v[84:87], v13, s[44:47], s97 offen offset:0
    s_waitcnt vmcnt(1)
    buffer_load_dwordx4 v[88:91], v13, s[44:47], s97 offen offset:256
    s_waitcnt vmcnt(1)
    buffer_load_dwordx4 v[92:95], v13, s[44:47], s97 offen offset:512
    s_waitcnt vmcnt(1)
    buffer_load_dwordx4 v[96:99], v13, s[44:47], s97 offen offset:768
    s_waitcnt vmcnt(1)
    buffer_load_dwordx4 v[100:103], v13, s[44:47], s97 offen offset:1024
    s_add_u32 s97, s97, 1280
    s_waitcnt vmcnt(1)
    buffer_load_dwordx4 v[104:107], v13, s[44:47], s97 offen offset:0
    s_waitcnt vmcnt(1)
    buffer_load_dwordx4 v[108:111], v13, s[44:47], s97 offen offset:256
    s_waitcnt vmcnt(1)
    buffer_load_dwordx4 v[112:115], v13, s[44:47], s97 offen offset:512
    s_waitcnt vmcnt(1)
    buffer_load_dwordx4 v[116:119], v13, s[44:47], s97 offen offset:768
    s_waitcnt vmcnt(1)
    buffer_load_dwordx4 v[120:123], v13, s[44:47], s97 offen offset:1024
    s_add_u32 s97, s97, 1280
    s_waitcnt vmcnt(1)
    buffer_load_dwordx4 v[124:127], v13, s[44:47], s97 offen offset:0
    s_waitcnt vmcnt(1)
    buffer_load_dwordx4 v[128:131], v13, s[44:47], s97 offen offset:256
    s_waitcnt vmcnt(1)
    buffer_load_dwordx4 v[132:135], v13, s[44:47], s97 offen offset:512
    s_waitcnt vmcnt(1)
    buffer_load_dwordx4 v[136:139], v13, s[44:47], s97 offen offset:768
    s_waitcnt vmcnt(1)
    buffer_load_dwordx4 v[140:143], v13, s[44:47], s97 offen offset:1024
    s_add_u32 s97, s97, 1280
    s_waitcnt vmcnt(1)
    buffer_load_dwordx4 v[144:147], v13, s[44:47], s97 offen offset:0
    s_waitcnt vmcnt(1)
    buffer_load_dwordx4 v[148:151], v13, s[44:47], s97 offen offset:256
    s_waitcnt vmcnt(1)
    buffer_load_dwordx4 v[152:155], v13, s[44:47], s97 offen offset:512
    s_waitcnt vmcnt(1)
    buffer_load_dwordx4 v[156:159], v13, s[44:47], s97 offen offset:768
    s_waitcnt vmcnt(1)
    buffer_load_dwordx4 v[160:163], v13, s[44:47], s97 offen offset:1024
    s_add_u32 s97, s97, 1280
    s_waitcnt vmcnt(1)
    buffer_load_dwordx4 v[164:167], v13, s[44:47], s97 offen offset:0
    s_waitcnt vmcnt(1)
    buffer_load_dwordx4 v[168:171], v13, s[44:47], s97 offen offset:256
    s_waitcnt vmcnt(1)
    buffer_load_dwordx4 v[172:175], v13, s[44:47], s97 offen offset:512
    s_waitcnt vmcnt(1)
    buffer_load_dwordx4 v[176:179], v13, s[44:47], s97 offen offset:768
    s_waitcnt vmcnt(1)
    buffer_load_dwordx4 v[180:183], v13, s[44:47], s97 offen offset:1024
    s_add_u32 s97, s97, 1280
    s_waitcnt vmcnt(1)
    buffer_load_dwordx4 v[184:187], v13, s[44:47], s97 offen offset:0
    s_waitcnt vmcnt(1)
    buffer_load_dwordx4 v[188:191], v13, s[44:47], s97 offen offset:256
    s_waitcnt vmcnt(1)
    buffer_load_dwordx4 v[192:195], v13, s[44:47], s97 offen offset:512
    s_waitcnt vmcnt(1)
    buffer_load_dwordx4 v[196:199], v13, s[44:47], s97 offen offset:768
    s_waitcnt vmcnt(1)
    buffer_load_dwordx4 v[200:203], v13, s[44:47], s97 offen offset:1024
    s_add_u32 s97, s97, 1280
    s_waitcnt vmcnt(1)
    buffer_load_dwordx4 v[204:207], v13, s[44:47], s97 offen offset:0
    s_waitcnt vmcnt(1)
    buffer_load_dwordx4 v[208:211], v13, s[44:47], s97 offen offset:256
    s_waitcnt vmcnt(1)
    buffer_load_dwordx4 v[212:215], v13, s[44:47], s97 offen offset:512
    s_waitcnt vmcnt(1)
    buffer_load_dwordx4 v[216:219], v13, s[44:47], s97 offen offset:768
    s_waitcnt vmcnt(1)
    buffer_load_dwordx4 v[220:223], v13, s[44:47], s97 offen offset:1024
    s_waitcnt vmcnt(0)
    s_mov_b32 s66, 0x05040100
    s_mov_b32 s67, 0x07060302
    v_perm_b32 v59, v84, v64, s66
    v_perm_b32 v84, v84, v64, s67
    v_mov_b32 v64, v59
    v_perm_b32 v59, v85, v65, s66
    v_perm_b32 v85, v85, v65, s67
    v_mov_b32 v65, v59
    v_perm_b32 v59, v86, v66, s66
    v_perm_b32 v86, v86, v66, s67
    v_mov_b32 v66, v59
    v_perm_b32 v59, v87, v67, s66
    v_perm_b32 v87, v87, v67, s67
    v_mov_b32 v67, v59
    v_perm_b32 v59, v88, v68, s66
    v_perm_b32 v88, v88, v68, s67
    v_mov_b32 v68, v59
    v_perm_b32 v59, v89, v69, s66
    v_perm_b32 v89, v89, v69, s67
    v_mov_b32 v69, v59
    v_perm_b32 v59, v90, v70, s66
    v_perm_b32 v90, v90, v70, s67
    v_mov_b32 v70, v59
    v_perm_b32 v59, v91, v71, s66
    v_perm_b32 v91, v91, v71, s67
    v_mov_b32 v71, v59
    v_perm_b32 v59, v92, v72, s66
    v_perm_b32 v92, v92, v72, s67
    v_mov_b32 v72, v59
    v_perm_b32 v59, v93, v73, s66
    v_perm_b32 v93, v93, v73, s67
    v_mov_b32 v73, v59
    v_perm_b32 v59, v94, v74, s66
    v_perm_b32 v94, v94, v74, s67
    v_mov_b32 v74, v59
    v_perm_b32 v59, v95, v75, s66
    v_perm_b32 v95, v95, v75, s67
    v_mov_b32 v75, v59
    v_perm_b32 v59, v96, v76, s66
    v_perm_b32 v96, v96, v76, s67
    v_mov_b32 v76, v59
    v_perm_b32 v59, v97, v77, s66
    v_perm_b32 v97, v97, v77, s67
    v_mov_b32 v77, v59
    v_perm_b32 v59, v98, v78, s66
    v_perm_b32 v98, v98, v78, s67
    v_mov_b32 v78, v59
    v_perm_b32 v59, v99, v79, s66
    v_perm_b32 v99, v99, v79, s67
    v_mov_b32 v79, v59
    v_perm_b32 v59, v100, v80, s66
    v_perm_b32 v100, v100, v80, s67
    v_mov_b32 v80, v59
    v_perm_b32 v59, v101, v81, s66
    v_perm_b32 v101, v101, v81, s67
    v_mov_b32 v81, v59
    v_perm_b32 v59, v102, v82, s66
    v_perm_b32 v102, v102, v82, s67
    v_mov_b32 v82, v59
    v_perm_b32 v59, v103, v83, s66
    v_perm_b32 v103, v103, v83, s67
    v_mov_b32 v83, v59
    v_perm_b32 v59, v124, v104, s66
    v_perm_b32 v124, v124, v104, s67
    v_mov_b32 v104, v59
    v_perm_b32 v59, v125, v105, s66
    v_perm_b32 v125, v125, v105, s67
    v_mov_b32 v105, v59
    v_perm_b32 v59, v126, v106, s66
    v_perm_b32 v126, v126, v106, s67
    v_mov_b32 v106, v59
    v_perm_b32 v59, v127, v107, s66
    v_perm_b32 v127, v127, v107, s67
    v_mov_b32 v107, v59
    v_perm_b32 v59, v128, v108, s66
    v_perm_b32 v128, v128, v108, s67
    v_mov_b32 v108, v59
    v_perm_b32 v59, v129, v109, s66
    v_perm_b32 v129, v129, v109, s67
    v_mov_b32 v109, v59
    v_perm_b32 v59, v130, v110, s66
    v_perm_b32 v130, v130, v110, s67
    v_mov_b32 v110, v59
    v_perm_b32 v59, v131, v111, s66
    v_perm_b32 v131, v131, v111, s67
    v_mov_b32 v111, v59
    v_perm_b32 v59, v132, v112, s66
    v_perm_b32 v132, v132, v112, s67
    v_mov_b32 v112, v59
    v_perm_b32 v59, v133, v113, s66
    v_perm_b32 v133, v133, v113, s67
    v_mov_b32 v113, v59
    v_perm_b32 v59, v134, v114, s66
    v_perm_b32 v134, v134, v114, s67
    v_mov_b32 v114, v59
    v_perm_b32 v59, v135, v115, s66
    v_perm_b32 v135, v135, v115, s67
    v_mov_b32 v115, v59
    v_perm_b32 v59, v136, v116, s66
    v_perm_b32 v136, v136, v116, s67
    v_mov_b32 v116, v59
    v_perm_b32 v59, v137, v117, s66
    v_perm_b32 v137, v137, v117, s67
    v_mov_b32 v117, v59
    v_perm_b32 v59, v138, v118, s66
    v_perm_b32 v138, v138, v118, s67
    v_mov_b32 v118, v59
    v_perm_b32 v59, v139, v119, s66
    v_perm_b32 v139, v139, v119, s67
    v_mov_b32 v119, v59
    v_perm_b32 v59, v140, v120, s66
    v_perm_b32 v140, v140, v120, s67
    v_mov_b32 v120, v59
    v_perm_b32 v59, v141, v121, s66
    v_perm_b32 v141, v141, v121, s67
    v_mov_b32 v121, v59
    v_perm_b32 v59, v142, v122, s66
    v_perm_b32 v142, v142, v122, s67
    v_mov_b32 v122, v59
    v_perm_b32 v59, v143, v123, s66
    v_perm_b32 v143, v143, v123, s67
    v_mov_b32 v123, v59
    v_perm_b32 v59, v164, v144, s66
    v_perm_b32 v164, v164, v144, s67
    v_mov_b32 v144, v59
    v_perm_b32 v59, v165, v145, s66
    v_perm_b32 v165, v165, v145, s67
    v_mov_b32 v145, v59
    v_perm_b32 v59, v166, v146, s66
    v_perm_b32 v166, v166, v146, s67
    v_mov_b32 v146, v59
    v_perm_b32 v59, v167, v147, s66
    v_perm_b32 v167, v167, v147, s67
    v_mov_b32 v147, v59
    v_perm_b32 v59, v168, v148, s66
    v_perm_b32 v168, v168, v148, s67
    v_mov_b32 v148, v59
    v_perm_b32 v59, v169, v149, s66
    v_perm_b32 v169, v169, v149, s67
    v_mov_b32 v149, v59
    v_perm_b32 v59, v170, v150, s66
    v_perm_b32 v170, v170, v150, s67
    v_mov_b32 v150, v59
    v_perm_b32 v59, v171, v151, s66
    v_perm_b32 v171, v171, v151, s67
    v_mov_b32 v151, v59
    v_perm_b32 v59, v172, v152, s66
    v_perm_b32 v172, v172, v152, s67
    v_mov_b32 v152, v59
    v_perm_b32 v59, v173, v153, s66
    v_perm_b32 v173, v173, v153, s67
    v_mov_b32 v153, v59
    v_perm_b32 v59, v174, v154, s66
    v_perm_b32 v174, v174, v154, s67
    v_mov_b32 v154, v59
    v_perm_b32 v59, v175, v155, s66
    v_perm_b32 v175, v175, v155, s67
    v_mov_b32 v155, v59
    v_perm_b32 v59, v176, v156, s66
    v_perm_b32 v176, v176, v156, s67
    v_mov_b32 v156, v59
    v_perm_b32 v59, v177, v157, s66
    v_perm_b32 v177, v177, v157, s67
    v_mov_b32 v157, v59
    v_perm_b32 v59, v178, v158, s66
    v_perm_b32 v178, v178, v158, s67
    v_mov_b32 v158, v59
    v_perm_b32 v59, v179, v159, s66
    v_perm_b32 v179, v179, v159, s67
    v_mov_b32 v159, v59
    v_perm_b32 v59, v180, v160, s66
    v_perm_b32 v180, v180, v160, s67
    v_mov_b32 v160, v59
    v_perm_b32 v59, v181, v161, s66
    v_perm_b32 v181, v181, v161, s67
    v_mov_b32 v161, v59
    v_perm_b32 v59, v182, v162, s66
    v_perm_b32 v182, v182, v162, s67
    v_mov_b32 v162, v59
    v_perm_b32 v59, v183, v163, s66
    v_perm_b32 v183, v183, v163, s67
    v_mov_b32 v163, v59
    v_perm_b32 v59, v204, v184, s66
    v_perm_b32 v204, v204, v184, s67
    v_mov_b32 v184, v59
    v_perm_b32 v59, v205, v185, s66
    v_perm_b32 v205, v205, v185, s67
    v_mov_b32 v185, v59
    v_perm_b32 v59, v206, v186, s66
    v_perm_b32 v206, v206, v186, s67
    v_mov_b32 v186, v59
    v_perm_b32 v59, v207, v187, s66
    v_perm_b32 v207, v207, v187, s67
    v_mov_b32 v187, v59
    v_perm_b32 v59, v208, v188, s66
    v_perm_b32 v208, v208, v188, s67
    v_mov_b32 v188, v59
    v_perm_b32 v59, v209, v189, s66
    v_perm_b32 v209, v209, v189, s67
    v_mov_b32 v189, v59
    v_perm_b32 v59, v210, v190, s66
    v_perm_b32 v210, v210, v190, s67
    v_mov_b32 v190, v59
    v_perm_b32 v59, v211, v191, s66
    v_perm_b32 v211, v211, v191, s67
    v_mov_b32 v191, v59
    v_perm_b32 v59, v212, v192, s66
    v_perm_b32 v212, v212, v192, s67
    v_mov_b32 v192, v59
    v_perm_b32 v59, v213, v193, s66
    v_perm_b32 v213, v213, v193, s67
    v_mov_b32 v193, v59
    v_perm_b32 v59, v214, v194, s66
    v_perm_b32 v214, v214, v194, s67
    v_mov_b32 v194, v59
    v_perm_b32 v59, v215, v195, s66
    v_perm_b32 v215, v215, v195, s67
    v_mov_b32 v195, v59
    v_perm_b32 v59, v216, v196, s66
    v_perm_b32 v216, v216, v196, s67
    v_mov_b32 v196, v59
    v_perm_b32 v59, v217, v197, s66
    v_perm_b32 v217, v217, v197, s67
    v_mov_b32 v197, v59
    v_perm_b32 v59, v218, v198, s66
    v_perm_b32 v218, v218, v198, s67
    v_mov_b32 v198, v59
    v_perm_b32 v59, v219, v199, s66
    v_perm_b32 v219, v219, v199, s67
    v_mov_b32 v199, v59
    v_perm_b32 v59, v220, v200, s66
    v_perm_b32 v220, v220, v200, s67
    v_mov_b32 v200, v59
    v_perm_b32 v59, v221, v201, s66
    v_perm_b32 v221, v221, v201, s67
    v_mov_b32 v201, v59
    v_perm_b32 v59, v222, v202, s66
    v_perm_b32 v222, v222, v202, s67
    v_mov_b32 v202, v59
    v_perm_b32 v59, v223, v203, s66
    v_perm_b32 v223, v223, v203, s67
    v_mov_b32 v203, v59
    s_cmp_lg_u32 s3, 4
    s_cbranch_scc1 L_xdone_64
    v_mov_b32 v8, 0
L_xspin_65:
    ds_read_b32 v9, v8 offset:2000
    s_waitcnt lgkmcnt(0)
    v_readfirstlane_b32 s59, v9
    s_nop 0
    s_cmp_ge_u32 s59, 85
    s_cbranch_scc1 L_xok_66
    s_sleep 8
    s_branch L_xspin_65
L_xok_66:
    ds_read_b32 v10, v8 offset:2028
    ds_read_b32 v11, v8 offset:2032
    s_waitcnt lgkmcnt(0)
    v_readfirstlane_b32 s60, v10
    v_readfirstlane_b32 s61, v11
    s_nop 0
    s_lshr_b32 s62, s61, 12
    s_and_b32 s62, s62, 0xffff
    s_lshl_b32 s63, s62, 16
    s_sub_u32 s66, s61, s0
    s_and_b32 s66, s66, 0xffff
    s_or_b32 s66, s66, s63
    s_sub_u32 s67, s61, s60
    s_and_b32 s67, s67, 0xffff
    s_or_b32 s67, s67, s63
    v_mov_b32 v10, s66
    v_mov_b32 v11, s67
    s_mul_i32 s59, s2, 37
    s_and_b32 s59, s59, 255
    s_lshl_b32 s59, s59, 3
    s_add_u32 s59, s59, 100352
    s_mov_b64 exec, 1
    buffer_store_dwordx2 v[10:11], v8, s[52:55], s59 offen sc1
    s_mov_b64 exec, -1
L_xspin_67:
    ds_read_b32 v9, v8 offset:2000
    s_waitcnt lgkmcnt(0)
    v_readfirstlane_b32 s59, v9
    s_nop 0
    s_cmp_ge_u32 s59, 89
    s_cbranch_scc1 L_xok_68
    s_sleep 8
    s_branch L_xspin_67
L_xok_68:
    v_lshlrev_b32 v9, 4, v1
    s_mov_b32 s59, 100352
    buffer_load_dwordx4 v[16:19], v9, s[52:55], s59 offen sc1
    buffer_load_dwordx4 v[20:23], v9, s[52:55], s59 offen offset:1024 sc1
    v_mov_b32 v24, 0
    v_mov_b32 v25, 0
    v_mov_b32 v26, 0
    s_add_u32 s62, s62, 1
    s_waitcnt vmcnt(0)
    v_lshrrev_b32 v27, 16, v16
    v_lshrrev_b32 v28, 16, v17
    v_cmp_eq_u32 vcc, v27, v28
    v_sub_u32 v27, s62, v27
    v_and_b32 v27, 0xffff, v27
    v_cmp_ge_u32 s[66:67], 2, v27
    s_nop 0
    s_and_b64 vcc, vcc, s[66:67]
    v_and_b32 v16, 0xffff, v16
    v_and_b32 v17, 0xffff, v17
    v_cndmask_b32 v16, 0, v16, vcc
    v_cndmask_b32 v17, 0, v17, vcc
    v_cndmask_b32 v27, 0, 1, vcc
    v_add_u32 v24, v24, v16
    v_add_u32 v25, v25, v17
    v_add_u32 v26, v26, v27
    v_lshrrev_b32 v27, 16, v18
    v_lshrrev_b32 v28, 16, v19
    v_cmp_eq_u32 vcc, v27, v28
    v_sub_u32 v27, s62, v27
    v_and_b32 v27, 0xffff, v27
    v_cmp_ge_u32 s[66:67], 2, v27
    s_nop 0
    s_and_b64 vcc, vcc, s[66:67]
    v_and_b32 v18, 0xffff, v18
    v_and_b32 v19, 0xffff, v19
    v_cndmask_b32 v18, 0, v18, vcc
    v_cndmask_b32 v19, 0, v19, vcc
    v_cndmask_b32 v27, 0, 1, vcc
    v_add_u32 v24, v24, v18
    v_add_u32 v25, v25, v19
    v_add_u32 v26, v26, v27
    v_lshrrev_b32 v27, 16, v20
    v_lshrrev_b32 v28, 16, v21
    v_cmp_eq_u32 vcc, v27, v28
    v_sub_u32 v27, s62, v27
    v_and_b32 v27, 0xffff, v27
    v_cmp_ge_u32 s[66:67], 2, v27
    s_nop 0
    s_and_b64 vcc, vcc, s[66:67]
    v_and_b32 v20, 0xffff, v20
    v_and_b32 v21, 0xffff, v21
    v_cndmask_b32 v20, 0, v20, vcc
    v_cndmask_b32 v21, 0, v21, vcc
    v_cndmask_b32 v27, 0, 1, vcc
    v_add_u32 v24, v24, v20
    v_add_u32 v25, v25, v21
    v_add_u32 v26, v26, v27
    v_lshrrev_b32 v27, 16, v22
    v_lshrrev_b32 v28, 16, v23
    v_cmp_eq_u32 vcc, v27, v28
    v_sub_u32 v27, s62, v27
    v_and_b32 v27, 0xffff, v27
    v_cmp_ge_u32 s[66:67], 2, v27
    s_nop 0
    s_and_b64 vcc, vcc, s[66:67]
    v_and_b32 v22, 0xffff, v22
    v_and_b32 v23, 0xffff, v23
    v_cndmask_b32 v22, 0, v22, vcc
    v_cndmask_b32 v23, 0, v23, vcc
    v_cndmask_b32 v27, 0, 1, vcc
    v_add_u32 v24, v24, v22
    v_add_u32 v25, v25, v23
    v_add_u32 v26, v26, v27
    v_cvt_f32_u32 v24, v24
    v_cvt_f32_u32 v25, v25
    v_cvt_f32_u32 v26, v26
    v_add_f32_dpp v24, v24, v24 row_ror:8 row_mask:0xf bank_mask:0xf
    v_add_f32_dpp v25, v25, v25 row_ror:8 row_mask:0xf bank_mask:0xf
    v_add_f32_dpp v26, v26, v26 row_ror:8 row_mask:0xf bank_mask:0xf
    v_add_f32_dpp v24, v24, v24 row_ror:4 row_mask:0xf bank_mask:0xf
    v_add_f32_dpp v25, v25, v25 row_ror:4 row_mask:0xf bank_mask:0xf
    v_add_f32_dpp v26, v26, v26 row_ror:4 row_mask:0xf bank_mask:0xf
    v_add_f32_dpp v24, v24, v24 row_ror:2 row_mask:0xf bank_mask:0xf
    v_add_f32_dpp v25, v25, v25 row_ror:2 row_mask:0xf bank_mask:0xf
    v_add_f32_dpp v26, v26, v26 row_ror:2 row_mask:0xf bank_mask:0xf
    v_add_f32_dpp v24, v24, v24 row_ror:1 row_mask:0xf bank_mask:0xf
    v_add_f32_dpp v25, v25, v25 row_ror:1 row_mask:0xf bank_mask:0xf
    v_add_f32_dpp v26, v26, v26 row_ror:1 row_mask:0xf bank_mask:0xf
    v_readlane_b32 s66, v24, 0
    v_readlane_b32 s67, v24, 16
    v_readlane_b32 s68, v24, 32
    v_readlane_b32 s69, v24, 48
    v_mov_b32 v27, s66
    v_add_f32 v27, s67, v27
    v_add_f32 v27, s68, v27
    v_add_f32 v24, s69, v27
    v_readlane_b32 s66, v25, 0
    v_readlane_b32 s67, v25, 16
    v_readlane_b32 s68, v25, 32
    v_readlane_b32 s69, v25, 48
    v_mov_b32 v27, s66
    v_add_f32 v27, s67, v27
    v_add_f32 v27, s68, v27
    v_add_f32 v25, s69, v27
    v_readlane_b32 s66, v26, 0
    v_readlane_b32 s67, v26, 16
    v_readlane_b32 s68, v26, 32
    v_readlane_b32 s69, v26, 48
    v_mov_b32 v27, s66
    v_add_f32 v27, s67, v27
    v_add_f32 v27, s68, v27
    v_add_f32 v26, s69, v27
    s_nop 0
    v_readfirstlane_b32 s59, v26
    s_nop 0
    s_cmp_eq_u32 s59, 0
    s_cbranch_scc1 L_xdone_64
    v_rcp_f32 v26, v26
    s_nop 0
    v_mul_f32 v24, v24, v26
    v_mul_f32 v25, v25, v26
    v_mul_f32 v25, 0x3eac5f93, v25
    v_mul_f32 v26, 0x40400000, v25
    v_sub_f32 v24, v24, v26
    v_cvt_u32_f32 v24, v24
    v_cvt_u32_f32 v25, v25
    v_add_u32 v24, s0, v24
    ds_write_b64 v8, v[24:25] offset:2016
    s_waitcnt lgkmcnt(0)
L_xdone_64:
    s_mov_b64 exec, 0
    s_cmp_eq_u32 s98, 0
    s_cbranch_scc1 wb_s0_p0
    s_cmp_eq_u32 s98, 1
    s_cbranch_scc1 wb_s1_p0
    s_cmp_eq_u32 s98, 2
    s_cbranch_scc1 wb_s2_p0
    s_cmp_eq_u32 s98, 3
    s_cbranch_scc1 wb_s3_p0
wb_ret:
    s_mov_b64 exec, -1
    s_waitcnt vmcnt(0) lgkmcnt(0)
    s_branch L_aux_epi
L_end:
    s_endpgm
.section .rodata,"a"
.p2align 6
.amdhsa_kernel recurrent_scan__mha_block_cached__dense_activation_squared_relu__decode_kernel
  .amdhsa_next_free_vgpr 256
  .amdhsa_next_free_sgpr 102
  .amdhsa_accum_offset 256
  .amdhsa_group_segment_fixed_size 0
  .amdhsa_kernarg_size 104
  .amdhsa_user_sgpr_count 2
  .amdhsa_user_sgpr_kernarg_segment_ptr 1
  .amdhsa_system_sgpr_workgroup_id_x 1
.end_amdhsa_kernel
```
